```python
import torch

def _softmax(x, axis=-1):
    return torch.softmax(x, dim=axis)

def _gelu(x):
    return torch.nn.functional.gelu(x, approximate='tanh')

def _silu(x):
    return torch.nn.functional.silu(x)

def _sigmoid(x):
    return torch.sigmoid(x)

def _layernorm(x, axis=-1, eps=1e-05):
    m = x.mean(dim=axis, keepdim=True)
    v = x.var(dim=axis, keepdim=True, unbiased=False)
    return (x - m) / torch.sqrt(v + eps)

def _scatter_add(tgt, idx, src, axis=0):
    return tgt.clone().index_add_(axis, idx, src)

def _segment_sum(src, seg, n):
    out = torch.zeros((n,) + src.shape[1:], dtype=src.dtype)
    return out.index_add_(0, seg, src)

def _pad(x, pw):
    flat = tuple((v for pair in reversed(pw) for v in pair))
    return torch.nn.functional.pad(x, flat)
kernel_name = 'gated_mix__softmax_full_mha__mixer_gmlp__prompt'

def setup_inputs():

    _w = lambda a: (lambda t: t.to(torch.bfloat16) if t.is_floating_point() else t)(torch.as_tensor(a))

    def _A_setup():
        B, S, D = (1, 2048, 640)
        return {'x': _w((lambda *s: torch.randn(*s, dtype=torch.bfloat16) * 0.05)(B, S, D)), 'wqkv': _w((lambda *s: torch.randn(*s, dtype=torch.bfloat16) * 0.8)(D, 3 * D)), 'wo': _w((lambda *s: torch.randn(*s, dtype=torch.bfloat16) * 0.1)(D, D))}
    _A_in = _A_setup()

    def _B_setup():
        B, S, D, F = (1, 2048, 640, 1728)
        Fh = F // 2
        return {'x': _w((lambda *s: torch.randn(*s, dtype=torch.bfloat16) * 0.05)(B, S, D)), 'w_in': _w((lambda *s: torch.randn(*s, dtype=torch.bfloat16) * 0.4)(D, 2 * Fh)), 'w_sp': _w(0.01 * (lambda *s: torch.randn(*s, dtype=torch.bfloat16) * 0.4)(S, S)), 'b_sp': _w(1.0 + 0.01 * (lambda *s: torch.randn(*s, dtype=torch.bfloat16) * 0.05)(S)), 'w_out': _w((lambda *s: torch.randn(*s, dtype=torch.bfloat16) * 0.05)(Fh, D))}
    _B_in = _B_setup()
    return {'A_x': _A_in['x'], 'A_wqkv': _A_in['wqkv'], 'A_wo': _A_in['wo'], 'B_x': _B_in['x'], 'B_w_in': _B_in['w_in'], 'B_w_sp': _B_in['w_sp'], 'B_b_sp': _B_in['b_sp'], 'B_w_out': _B_in['w_out'], 'gate_w': _w((lambda *s: torch.randn(*s, dtype=torch.bfloat16) * 0.05)(640) * 16.0)}

def reference(A_x, A_wqkv, A_wo, B_x, B_w_in, B_w_sp, B_b_sp, B_w_out, gate_w):

    def _A_ref(x, wqkv, wo):
        B, S, D = x.shape
        H = 32
        Dh = D // H
        qkv = (lambda x, *d: x.permute(*d))((x @ wqkv).reshape(B, S, 3, H, Dh), 2, 0, 3, 1, 4)
        q, k, v = (qkv[0], qkv[1], qkv[2])
        scale = Dh ** (-0.5)
        scores = torch.einsum('bhqd,bhkd->bhqk', q, k) * scale
        p = _softmax(scores, axis=-1)
        o = torch.einsum('bhqk,bhkd->bhqd', p, v)
        return (lambda x, *d: x.permute(*d))(o, 0, 2, 1, 3).reshape(B, S, D) @ wo

    def _B_ref(x, w_in, w_sp, b_sp, w_out):
        B, S, D = x.shape
        F = w_in.shape[-1]
        Fh = F // 2
        z = _gelu(torch.einsum('bsd,df->bsf', x, w_in))
        z1 = z[..., :Fh].clone()
        z2 = _layernorm(z[..., Fh:], axis=-1)
        g = torch.einsum('ts,bsf->btf', w_sp, z2) + b_sp[None, :, None]
        return torch.einsum('bsf,fd->bsd', z1 * g, w_out)
    x = A_x
    g = _sigmoid((x * gate_w).sum(-1, keepdims=True))
    a = _A_ref(x, A_wqkv, A_wo)
    b = _B_ref(x, B_w_in, B_w_sp, B_b_sp, B_w_out)
    return g * a + (1 - g) * b
```

```asm
; @launch kernel=k1_kernel grid=(256,1,1) block=(768,1,1) lds=147456
; @launch kernel=k2_kernel grid=(512,1,1) block=(512,1,1) lds=81920
.amdgcn_target "amdgcn-amd-amdhsa--gfx950"
.text
.globl k1_kernel
.p2align 8
.type k1_kernel,@function
k1_kernel:
  s_cmp_ge_u32 s2, 256
  s_cbranch_scc1 L_k1_end
  s_load_dwordx16 s[4:19], s[0:1], 0
  s_load_dwordx8 s[20:27], s[0:1], 64
  v_and_b32 v1, 63, v0
  v_lshrrev_b32 v16, 6, v0
  s_and_b32 s60, s2, 7
  s_lshr_b32 s61, s2, 3
  v_readfirstlane_b32 s40, v16
  s_lshr_b32 s62, s60, 2
  s_lshl_b32 s62, s62, 3
  s_lshr_b32 s63, s61, 2
  s_add_u32 s44, s62, s63
  s_and_b32 s62, s60, 3
  s_lshl_b32 s62, s62, 2
  s_and_b32 s63, s61, 3
  s_add_u32 s45, s62, s63
  s_cmp_eq_u32 s45, 15
  s_cbranch_scc1 L_k1_misc
  s_cmp_eq_u32 s40, 12
  s_cbranch_scc1 L_k1_pf
  s_cmp_ge_u32 s40, 8
  s_cbranch_scc1 L_k1_prod
  s_lshr_b32 s43, s40, 2
  s_and_b32 s41, s40, 1
  s_lshr_b32 s42, s40, 1
  v_lshrrev_b32 v17, 4, v1
  v_and_b32 v18, 15, v1
  v_and_b32 v20, 31, v1
  v_lshrrev_b32 v21, 5, v1
  v_bfe_u32 v22, v20, 1, 3
  v_xor_b32 v22, v22, v21
  v_lshlrev_b32 v22, 4, v22
  s_lshl_b32 s62, s41, 13
  v_lshl_add_u32 v23, v20, 7, v22
  v_add_u32 v2, s62, v23
  v_xor_b32 v3, 32, v2
  v_xor_b32 v4, 64, v2
  v_xor_b32 v5, 96, v2
  v_and_b32 v22, 1, v17
  v_lshrrev_b32 v23, 2, v18
  v_and_b32 v24, 3, v1
  v_lshrrev_b32 v25, 1, v24
  v_lshl_add_u32 v25, v22, 1, v25
  s_lshl_b32 s62, s42, 2
  v_add_u32 v25, s62, v25
  v_lshlrev_b32 v26, 2, v23
  v_xor_b32 v25, v25, v26
  v_lshl_add_u32 v26, v21, 3, v23
  v_lshlrev_b32 v26, 8, v26
  v_lshl_add_u32 v26, v25, 4, v26
  v_and_b32 v24, 1, v24
  v_lshl_add_u32 v26, v24, 3, v26
  v_add_u32 v6, 16384, v26
  v_add_u32 v7, 32768, v26
  s_lshl_b32 s72, s45, 7
  s_lshl_b32 s73, s42, 5
  s_add_u32 s72, s72, s73
  s_cmp_ge_u32 s72, 640
  s_cselect_b32 s58, 1, 0
  s_cmp_ge_u32 s72, 1280
  s_cselect_b32 s58, 2, s58
  s_cmp_eq_u32 s58, 0
  s_cselect_b32 s54, 1, 0
  s_mul_i32 s59, s58, 640
  s_sub_u32 s72, s72, s59
  s_mul_i32 s66, s58, 3
  s_lshl_b32 s66, s66, 15
  s_cmp_eq_u32 s58, 0
  s_mov_b32 s67, 163840
  s_cselect_b32 s67, 65536, s67
  s_cmp_eq_u32 s58, 2
  s_cselect_b32 s59, 8, 0
  s_add_u32 s67, s67, s59
  s_add_u32 s73, s72, 0
  s_mul_i32 s59, s73, 1639
  s_lshr_b32 s59, s59, 16
  s_mul_i32 s60, s59, 40
  s_sub_u32 s60, s73, s60
  s_lshl_b32 s61, s59, 19
  s_cmp_ge_u32 s60, 24
  s_cselect_b32 s64, 262144, 0
  s_add_u32 s64, s64, s61
  s_cmp_eq_u32 s60, 8
  s_cselect_b32 s65, 32768, 0
  s_cmp_eq_u32 s60, 32
  s_cselect_b32 s65, 32768, s65
  s_add_u32 s64, s64, s65
  s_add_u32 s64, s64, s66
  s_add_u32 s65, s61, s67
  s_add_u32 s68, s65, 262144
  s_cmp_eq_u32 s60, 16
  s_cselect_b32 s46, 2130706432, s64
  s_cselect_b32 s50, s65, 2130706432
  s_cselect_b32 s74, s68, 2130706432
  s_cselect_b32 s69, 2, 0
  s_or_b32 s54, s54, s69
  s_add_u32 s73, s72, 8
  s_mul_i32 s59, s73, 1639
  s_lshr_b32 s59, s59, 16
  s_mul_i32 s60, s59, 40
  s_sub_u32 s60, s73, s60
  s_lshl_b32 s61, s59, 19
  s_cmp_ge_u32 s60, 24
  s_cselect_b32 s64, 262144, 0
  s_add_u32 s64, s64, s61
  s_cmp_eq_u32 s60, 8
  s_cselect_b32 s65, 32768, 0
  s_cmp_eq_u32 s60, 32
  s_cselect_b32 s65, 32768, s65
  s_add_u32 s64, s64, s65
  s_add_u32 s64, s64, s66
  s_add_u32 s65, s61, s67
  s_add_u32 s68, s65, 262144
  s_cmp_eq_u32 s60, 16
  s_cselect_b32 s47, 2130706432, s64
  s_cselect_b32 s51, s65, 2130706432
  s_cselect_b32 s75, s68, 2130706432
  s_cselect_b32 s69, 2, 0
  s_or_b32 s54, s54, s69
  s_add_u32 s73, s72, 16
  s_mul_i32 s59, s73, 1639
  s_lshr_b32 s59, s59, 16
  s_mul_i32 s60, s59, 40
  s_sub_u32 s60, s73, s60
  s_lshl_b32 s61, s59, 19
  s_cmp_ge_u32 s60, 24
  s_cselect_b32 s64, 262144, 0
  s_add_u32 s64, s64, s61
  s_cmp_eq_u32 s60, 8
  s_cselect_b32 s65, 32768, 0
  s_cmp_eq_u32 s60, 32
  s_cselect_b32 s65, 32768, s65
  s_add_u32 s64, s64, s65
  s_add_u32 s64, s64, s66
  s_add_u32 s65, s61, s67
  s_add_u32 s68, s65, 262144
  s_cmp_eq_u32 s60, 16
  s_cselect_b32 s48, 2130706432, s64
  s_cselect_b32 s52, s65, 2130706432
  s_cselect_b32 s76, s68, 2130706432
  s_cselect_b32 s69, 4, 0
  s_or_b32 s54, s54, s69
  s_add_u32 s73, s72, 24
  s_mul_i32 s59, s73, 1639
  s_lshr_b32 s59, s59, 16
  s_mul_i32 s60, s59, 40
  s_sub_u32 s60, s73, s60
  s_lshl_b32 s61, s59, 19
  s_cmp_ge_u32 s60, 24
  s_cselect_b32 s64, 262144, 0
  s_add_u32 s64, s64, s61
  s_cmp_eq_u32 s60, 8
  s_cselect_b32 s65, 32768, 0
  s_cmp_eq_u32 s60, 32
  s_cselect_b32 s65, 32768, s65
  s_add_u32 s64, s64, s65
  s_add_u32 s64, s64, s66
  s_add_u32 s65, s61, s67
  s_add_u32 s68, s65, 262144
  s_cmp_eq_u32 s60, 16
  s_cselect_b32 s49, 2130706432, s64
  s_cselect_b32 s53, s65, 2130706432
  s_cselect_b32 s77, s68, 2130706432
  s_cselect_b32 s69, 4, 0
  s_or_b32 s54, s54, s69
  v_mov_b32 v64, 0
  v_mov_b32 v65, 0
  v_mov_b32 v66, 0
  v_mov_b32 v67, 0
  v_mov_b32 v68, 0
  v_mov_b32 v69, 0
  v_mov_b32 v70, 0
  v_mov_b32 v71, 0
  v_mov_b32 v72, 0
  v_mov_b32 v73, 0
  v_mov_b32 v74, 0
  v_mov_b32 v75, 0
  v_mov_b32 v76, 0
  v_mov_b32 v77, 0
  v_mov_b32 v78, 0
  v_mov_b32 v79, 0
  v_mov_b32 v80, 0
  v_mov_b32 v81, 0
  v_mov_b32 v82, 0
  v_mov_b32 v83, 0
  v_mov_b32 v84, 0
  v_mov_b32 v85, 0
  v_mov_b32 v86, 0
  v_mov_b32 v87, 0
  v_mov_b32 v88, 0
  v_mov_b32 v89, 0
  v_mov_b32 v90, 0
  v_mov_b32 v91, 0
  v_mov_b32 v92, 0
  v_mov_b32 v93, 0
  v_mov_b32 v94, 0
  v_mov_b32 v95, 0
  v_mov_b32 v96, 0
  v_mov_b32 v97, 0
  v_mov_b32 v98, 0
  v_mov_b32 v99, 0
  v_mov_b32 v100, 0
  v_mov_b32 v101, 0
  v_mov_b32 v102, 0
  v_mov_b32 v103, 0
  v_mov_b32 v104, 0
  v_mov_b32 v105, 0
  v_mov_b32 v106, 0
  v_mov_b32 v107, 0
  v_mov_b32 v108, 0
  v_mov_b32 v109, 0
  v_mov_b32 v110, 0
  v_mov_b32 v111, 0
  v_mov_b32 v112, 0
  v_mov_b32 v113, 0
  v_mov_b32 v114, 0
  v_mov_b32 v115, 0
  v_mov_b32 v116, 0
  v_mov_b32 v117, 0
  v_mov_b32 v118, 0
  v_mov_b32 v119, 0
  v_mov_b32 v120, 0
  v_mov_b32 v121, 0
  v_mov_b32 v122, 0
  v_mov_b32 v123, 0
  v_mov_b32 v124, 0
  v_mov_b32 v125, 0
  v_mov_b32 v126, 0
  v_mov_b32 v127, 0
  s_waitcnt lgkmcnt(0)
  s_barrier
  ds_read_b128 v[32:35], v2 offset:0
  ds_read_b128 v[36:39], v2 offset:4096
  ds_read_b64_tr_b16 v[40:41], v6 offset:0
  ds_read_b64_tr_b16 v[42:43], v6 offset:1024
  ds_read_b64_tr_b16 v[44:45], v7 offset:0
  ds_read_b64_tr_b16 v[46:47], v7 offset:1024
  s_mov_b32 s57, 0
  s_mov_b32 s56, 49152
L_loop_k1_1:
  s_waitcnt lgkmcnt(0)
  v_mfma_f32_32x32x16_bf16 v[64:79], v[40:43], v[32:35], v[64:79]
  ds_read_b128 v[48:51], v3 offset:0
  ds_read_b64_tr_b16 v[56:57], v6 offset:4096
  ds_read_b64_tr_b16 v[58:59], v6 offset:5120
  v_mfma_f32_32x32x16_bf16 v[80:95], v[40:43], v[36:39], v[80:95]
  ds_read_b128 v[52:55], v3 offset:4096
  ds_read_b64_tr_b16 v[60:61], v7 offset:4096
  ds_read_b64_tr_b16 v[62:63], v7 offset:5120
  v_mfma_f32_32x32x16_bf16 v[96:111], v[44:47], v[32:35], v[96:111]
  v_mfma_f32_32x32x16_bf16 v[112:127], v[44:47], v[36:39], v[112:127]
  s_waitcnt lgkmcnt(0)
  v_mfma_f32_32x32x16_bf16 v[64:79], v[56:59], v[48:51], v[64:79]
  ds_read_b128 v[32:35], v4 offset:0
  ds_read_b64_tr_b16 v[40:41], v6 offset:8192
  ds_read_b64_tr_b16 v[42:43], v6 offset:9216
  v_mfma_f32_32x32x16_bf16 v[80:95], v[56:59], v[52:55], v[80:95]
  ds_read_b128 v[36:39], v4 offset:4096
  ds_read_b64_tr_b16 v[44:45], v7 offset:8192
  ds_read_b64_tr_b16 v[46:47], v7 offset:9216
  v_mfma_f32_32x32x16_bf16 v[96:111], v[60:63], v[48:51], v[96:111]
  v_mfma_f32_32x32x16_bf16 v[112:127], v[60:63], v[52:55], v[112:127]
  s_waitcnt lgkmcnt(0)
  v_mfma_f32_32x32x16_bf16 v[64:79], v[40:43], v[32:35], v[64:79]
  ds_read_b128 v[48:51], v5 offset:0
  ds_read_b64_tr_b16 v[56:57], v6 offset:12288
  ds_read_b64_tr_b16 v[58:59], v6 offset:13312
  v_mfma_f32_32x32x16_bf16 v[80:95], v[40:43], v[36:39], v[80:95]
  ds_read_b128 v[52:55], v5 offset:4096
  ds_read_b64_tr_b16 v[60:61], v7 offset:12288
  ds_read_b64_tr_b16 v[62:63], v7 offset:13312
  v_mfma_f32_32x32x16_bf16 v[96:111], v[44:47], v[32:35], v[96:111]
  v_mfma_f32_32x32x16_bf16 v[112:127], v[44:47], v[36:39], v[112:127]
  s_waitcnt lgkmcnt(0)
  s_barrier
  v_add_u32 v2, s56, v2
  v_add_u32 v3, s56, v3
  v_add_u32 v4, s56, v4
  v_add_u32 v5, s56, v5
  v_add_u32 v6, s56, v6
  v_add_u32 v7, s56, v7
  v_mfma_f32_32x32x16_bf16 v[64:79], v[56:59], v[48:51], v[64:79]
  ds_read_b128 v[32:35], v2 offset:0
  ds_read_b64_tr_b16 v[40:41], v6 offset:0
  ds_read_b64_tr_b16 v[42:43], v6 offset:1024
  v_mfma_f32_32x32x16_bf16 v[80:95], v[56:59], v[52:55], v[80:95]
  ds_read_b128 v[36:39], v2 offset:4096
  ds_read_b64_tr_b16 v[44:45], v7 offset:0
  ds_read_b64_tr_b16 v[46:47], v7 offset:1024
  v_mfma_f32_32x32x16_bf16 v[96:111], v[60:63], v[48:51], v[96:111]
  v_mfma_f32_32x32x16_bf16 v[112:127], v[60:63], v[52:55], v[112:127]
  s_add_u32 s57, s57, 1
  s_mov_b32 s56, 49152
  s_cmp_eq_u32 s57, 2
  s_cselect_b32 s56, -98304, s56
  s_cmp_eq_u32 s57, 5
  s_cselect_b32 s56, -98304, s56
  s_cmp_eq_u32 s57, 8
  s_cselect_b32 s56, -98304, s56
  s_cmp_lt_u32 s57, 9
  s_cbranch_scc1 L_loop_k1_1
  s_waitcnt lgkmcnt(0)
  v_mfma_f32_32x32x16_bf16 v[64:79], v[40:43], v[32:35], v[64:79]
  ds_read_b128 v[48:51], v3 offset:0
  ds_read_b64_tr_b16 v[56:57], v6 offset:4096
  ds_read_b64_tr_b16 v[58:59], v6 offset:5120
  v_mfma_f32_32x32x16_bf16 v[80:95], v[40:43], v[36:39], v[80:95]
  ds_read_b128 v[52:55], v3 offset:4096
  ds_read_b64_tr_b16 v[60:61], v7 offset:4096
  ds_read_b64_tr_b16 v[62:63], v7 offset:5120
  v_mfma_f32_32x32x16_bf16 v[96:111], v[44:47], v[32:35], v[96:111]
  v_mfma_f32_32x32x16_bf16 v[112:127], v[44:47], v[36:39], v[112:127]
  s_waitcnt lgkmcnt(0)
  v_mfma_f32_32x32x16_bf16 v[64:79], v[56:59], v[48:51], v[64:79]
  ds_read_b128 v[32:35], v4 offset:0
  ds_read_b64_tr_b16 v[40:41], v6 offset:8192
  ds_read_b64_tr_b16 v[42:43], v6 offset:9216
  v_mfma_f32_32x32x16_bf16 v[80:95], v[56:59], v[52:55], v[80:95]
  ds_read_b128 v[36:39], v4 offset:4096
  ds_read_b64_tr_b16 v[44:45], v7 offset:8192
  ds_read_b64_tr_b16 v[46:47], v7 offset:9216
  v_mfma_f32_32x32x16_bf16 v[96:111], v[60:63], v[48:51], v[96:111]
  v_mfma_f32_32x32x16_bf16 v[112:127], v[60:63], v[52:55], v[112:127]
  s_waitcnt lgkmcnt(0)
  v_mfma_f32_32x32x16_bf16 v[64:79], v[40:43], v[32:35], v[64:79]
  ds_read_b128 v[48:51], v5 offset:0
  ds_read_b64_tr_b16 v[56:57], v6 offset:12288
  ds_read_b64_tr_b16 v[58:59], v6 offset:13312
  v_mfma_f32_32x32x16_bf16 v[80:95], v[40:43], v[36:39], v[80:95]
  ds_read_b128 v[52:55], v5 offset:4096
  ds_read_b64_tr_b16 v[60:61], v7 offset:12288
  ds_read_b64_tr_b16 v[62:63], v7 offset:13312
  v_mfma_f32_32x32x16_bf16 v[96:111], v[44:47], v[32:35], v[96:111]
  v_mfma_f32_32x32x16_bf16 v[112:127], v[44:47], v[36:39], v[112:127]
  s_waitcnt lgkmcnt(0)
  v_mfma_f32_32x32x16_bf16 v[64:79], v[56:59], v[48:51], v[64:79]
  v_mfma_f32_32x32x16_bf16 v[80:95], v[56:59], v[52:55], v[80:95]
  v_mfma_f32_32x32x16_bf16 v[96:111], v[60:63], v[48:51], v[96:111]
  v_mfma_f32_32x32x16_bf16 v[112:127], v[60:63], v[52:55], v[112:127]
  s_waitcnt vmcnt(0)
  s_nop 15
  s_lshl_b32 s62, s44, 7
  s_lshl_b32 s63, s41, 6
  s_add_u32 s62, s62, s63
  v_add_u32 v16, s62, v20
  v_lshlrev_b32 v16, 4, v16
  s_cmp_eq_u32 s45, 15
  s_cbranch_scc1 L_k1_2
  s_mov_b32 s36, s26
  s_mov_b32 s37, s27
  s_mov_b32 s38, 0x800000
  s_mov_b32 s39, 0x20000
  s_bitcmp1_b32 s54, 0
  s_mov_b32 s62, 0x3ea52b5c
  s_cselect_b32 s62, s62, 1.0
  s_mov_b32 s63, s62
  v_cmp_eq_u32 vcc, 1, v21
  v_pk_mul_f32 v[64:65], v[64:65], s[62:63]
  v_pk_mul_f32 v[66:67], v[66:67], s[62:63]
  v_pk_mul_f32 v[68:69], v[68:69], s[62:63]
  v_pk_mul_f32 v[70:71], v[70:71], s[62:63]
  v_pk_mul_f32 v[72:73], v[72:73], s[62:63]
  v_pk_mul_f32 v[74:75], v[74:75], s[62:63]
  v_pk_mul_f32 v[76:77], v[76:77], s[62:63]
  v_pk_mul_f32 v[78:79], v[78:79], s[62:63]
  v_pk_mul_f32 v[80:81], v[80:81], s[62:63]
  v_pk_mul_f32 v[82:83], v[82:83], s[62:63]
  v_pk_mul_f32 v[84:85], v[84:85], s[62:63]
  v_pk_mul_f32 v[86:87], v[86:87], s[62:63]
  v_pk_mul_f32 v[88:89], v[88:89], s[62:63]
  v_pk_mul_f32 v[90:91], v[90:91], s[62:63]
  v_pk_mul_f32 v[92:93], v[92:93], s[62:63]
  v_pk_mul_f32 v[94:95], v[94:95], s[62:63]
  v_mov_b32 v22, s46
  v_mov_b32 v19, s47
  v_cndmask_b32 v22, v22, v19, vcc
  v_add_u32 v22, v22, v16
  v_cvt_pk_bf16_f32 v32, v64, v65
  v_cvt_pk_bf16_f32 v33, v66, v67
  v_cvt_pk_bf16_f32 v34, v68, v69
  v_cvt_pk_bf16_f32 v35, v70, v71
  v_cvt_pk_bf16_f32 v36, v80, v81
  v_cvt_pk_bf16_f32 v37, v82, v83
  v_cvt_pk_bf16_f32 v38, v84, v85
  v_cvt_pk_bf16_f32 v39, v86, v87
  s_nop 1
  v_permlane32_swap_b32 v32, v34
  v_permlane32_swap_b32 v33, v35
  v_permlane32_swap_b32 v36, v38
  v_permlane32_swap_b32 v37, v39
  buffer_store_dwordx4 v[32:35], v22, s[36:39], 0 offen offset:0
  buffer_store_dwordx4 v[36:39], v22, s[36:39], 0 offen offset:512
  s_bitcmp1_b32 s54, 1
  s_cbranch_scc0 L_k1_3
  v_mov_b32 v23, s50
  v_mov_b32 v19, s51
  v_cndmask_b32 v23, v23, v19, vcc
  v_add_u32 v23, v23, v16
  v_mov_b32 v24, s74
  v_mov_b32 v19, s75
  v_cndmask_b32 v24, v24, v19, vcc
  v_add_u32 v24, v24, v16
  buffer_store_dwordx2 v[32:33], v23, s[36:39], 0 offen offset:0
  buffer_store_dwordx2 v[34:35], v24, s[36:39], 0 offen offset:0
  buffer_store_dwordx2 v[36:37], v23, s[36:39], 0 offen offset:512
  buffer_store_dwordx2 v[38:39], v24, s[36:39], 0 offen offset:512
L_k1_3:
  v_mov_b32 v22, s48
  v_mov_b32 v19, s49
  v_cndmask_b32 v22, v22, v19, vcc
  v_add_u32 v22, v22, v16
  v_cvt_pk_bf16_f32 v40, v72, v73
  v_cvt_pk_bf16_f32 v41, v74, v75
  v_cvt_pk_bf16_f32 v42, v76, v77
  v_cvt_pk_bf16_f32 v43, v78, v79
  v_cvt_pk_bf16_f32 v44, v88, v89
  v_cvt_pk_bf16_f32 v45, v90, v91
  v_cvt_pk_bf16_f32 v46, v92, v93
  v_cvt_pk_bf16_f32 v47, v94, v95
  s_nop 1
  v_permlane32_swap_b32 v40, v42
  v_permlane32_swap_b32 v41, v43
  v_permlane32_swap_b32 v44, v46
  v_permlane32_swap_b32 v45, v47
  buffer_store_dwordx4 v[40:43], v22, s[36:39], 0 offen offset:0
  buffer_store_dwordx4 v[44:47], v22, s[36:39], 0 offen offset:512
  s_bitcmp1_b32 s54, 2
  s_cbranch_scc0 L_k1_4
  v_mov_b32 v23, s52
  v_mov_b32 v19, s53
  v_cndmask_b32 v23, v23, v19, vcc
  v_add_u32 v23, v23, v16
  v_mov_b32 v24, s76
  v_mov_b32 v19, s77
  v_cndmask_b32 v24, v24, v19, vcc
  v_add_u32 v24, v24, v16
  buffer_store_dwordx2 v[40:41], v23, s[36:39], 0 offen offset:0
  buffer_store_dwordx2 v[42:43], v24, s[36:39], 0 offen offset:0
  buffer_store_dwordx2 v[44:45], v23, s[36:39], 0 offen offset:512
  buffer_store_dwordx2 v[46:47], v24, s[36:39], 0 offen offset:512
L_k1_4:
L_k1_2:
  s_cmp_eq_u32 s45, 15
  s_cbranch_scc1 L_k1_gate
  s_lshl_b32 s70, s45, 2
  s_add_u32 s70, s70, s42
  s_cmp_ge_u32 s70, 54
  s_cbranch_scc1 L_k1_fin
  s_mov_b32 s68, 0xbdd2d3e8
  s_mov_b32 s69, 0xbdd2d3e8
  v_mov_b32 v30, 0xc0135761
  v_mov_b32 v31, 0xc0135761
  v_mov_b32 v40, 1.0
  v_mov_b32 v41, 1.0
  v_lshl_add_u32 v17, v21, 15, v16
  v_pk_mul_f32 v[32:33], v[96:97], v[96:97]
  v_pk_mul_f32 v[34:35], v[98:99], v[98:99]
  v_pk_mul_f32 v[36:37], v[100:101], v[100:101]
  v_pk_mul_f32 v[38:39], v[102:103], v[102:103]
  v_pk_fma_f32 v[32:33], v[32:33], s[68:69], v[30:31]
  v_pk_fma_f32 v[34:35], v[34:35], s[68:69], v[30:31]
  v_pk_fma_f32 v[36:37], v[36:37], s[68:69], v[30:31]
  v_pk_fma_f32 v[38:39], v[38:39], s[68:69], v[30:31]
  v_pk_mul_f32 v[32:33], v[32:33], v[96:97]
  v_pk_mul_f32 v[34:35], v[34:35], v[98:99]
  v_pk_mul_f32 v[36:37], v[36:37], v[100:101]
  v_pk_mul_f32 v[38:39], v[38:39], v[102:103]
  v_exp_f32 v32, v32
  v_exp_f32 v33, v33
  v_exp_f32 v34, v34
  v_exp_f32 v35, v35
  v_exp_f32 v36, v36
  v_exp_f32 v37, v37
  v_exp_f32 v38, v38
  v_exp_f32 v39, v39
  v_pk_add_f32 v[32:33], v[32:33], v[40:41]
  v_pk_add_f32 v[34:35], v[34:35], v[40:41]
  v_pk_add_f32 v[36:37], v[36:37], v[40:41]
  v_pk_add_f32 v[38:39], v[38:39], v[40:41]
  v_rcp_f32 v32, v32
  v_rcp_f32 v33, v33
  v_rcp_f32 v34, v34
  v_rcp_f32 v35, v35
  v_rcp_f32 v36, v36
  v_rcp_f32 v37, v37
  v_rcp_f32 v38, v38
  v_rcp_f32 v39, v39
  v_pk_mul_f32 v[96:97], v[96:97], v[32:33]
  v_pk_mul_f32 v[98:99], v[98:99], v[34:35]
  v_pk_mul_f32 v[100:101], v[100:101], v[36:37]
  v_pk_mul_f32 v[102:103], v[102:103], v[38:39]
  v_pk_mul_f32 v[32:33], v[104:105], v[104:105]
  v_pk_mul_f32 v[34:35], v[106:107], v[106:107]
  v_pk_mul_f32 v[36:37], v[108:109], v[108:109]
  v_pk_mul_f32 v[38:39], v[110:111], v[110:111]
  v_pk_fma_f32 v[32:33], v[32:33], s[68:69], v[30:31]
  v_pk_fma_f32 v[34:35], v[34:35], s[68:69], v[30:31]
  v_pk_fma_f32 v[36:37], v[36:37], s[68:69], v[30:31]
  v_pk_fma_f32 v[38:39], v[38:39], s[68:69], v[30:31]
  v_pk_mul_f32 v[32:33], v[32:33], v[104:105]
  v_pk_mul_f32 v[34:35], v[34:35], v[106:107]
  v_pk_mul_f32 v[36:37], v[36:37], v[108:109]
  v_pk_mul_f32 v[38:39], v[38:39], v[110:111]
  v_exp_f32 v32, v32
  v_exp_f32 v33, v33
  v_exp_f32 v34, v34
  v_exp_f32 v35, v35
  v_exp_f32 v36, v36
  v_exp_f32 v37, v37
  v_exp_f32 v38, v38
  v_exp_f32 v39, v39
  v_pk_add_f32 v[32:33], v[32:33], v[40:41]
  v_pk_add_f32 v[34:35], v[34:35], v[40:41]
  v_pk_add_f32 v[36:37], v[36:37], v[40:41]
  v_pk_add_f32 v[38:39], v[38:39], v[40:41]
  v_rcp_f32 v32, v32
  v_rcp_f32 v33, v33
  v_rcp_f32 v34, v34
  v_rcp_f32 v35, v35
  v_rcp_f32 v36, v36
  v_rcp_f32 v37, v37
  v_rcp_f32 v38, v38
  v_rcp_f32 v39, v39
  v_pk_mul_f32 v[104:105], v[104:105], v[32:33]
  v_pk_mul_f32 v[106:107], v[106:107], v[34:35]
  v_pk_mul_f32 v[108:109], v[108:109], v[36:37]
  v_pk_mul_f32 v[110:111], v[110:111], v[38:39]
  v_pk_mul_f32 v[32:33], v[112:113], v[112:113]
  v_pk_mul_f32 v[34:35], v[114:115], v[114:115]
  v_pk_mul_f32 v[36:37], v[116:117], v[116:117]
  v_pk_mul_f32 v[38:39], v[118:119], v[118:119]
  v_pk_fma_f32 v[32:33], v[32:33], s[68:69], v[30:31]
  v_pk_fma_f32 v[34:35], v[34:35], s[68:69], v[30:31]
  v_pk_fma_f32 v[36:37], v[36:37], s[68:69], v[30:31]
  v_pk_fma_f32 v[38:39], v[38:39], s[68:69], v[30:31]
  v_pk_mul_f32 v[32:33], v[32:33], v[112:113]
  v_pk_mul_f32 v[34:35], v[34:35], v[114:115]
  v_pk_mul_f32 v[36:37], v[36:37], v[116:117]
  v_pk_mul_f32 v[38:39], v[38:39], v[118:119]
  v_exp_f32 v32, v32
  v_exp_f32 v33, v33
  v_exp_f32 v34, v34
  v_exp_f32 v35, v35
  v_exp_f32 v36, v36
  v_exp_f32 v37, v37
  v_exp_f32 v38, v38
  v_exp_f32 v39, v39
  v_pk_add_f32 v[32:33], v[32:33], v[40:41]
  v_pk_add_f32 v[34:35], v[34:35], v[40:41]
  v_pk_add_f32 v[36:37], v[36:37], v[40:41]
  v_pk_add_f32 v[38:39], v[38:39], v[40:41]
  v_rcp_f32 v32, v32
  v_rcp_f32 v33, v33
  v_rcp_f32 v34, v34
  v_rcp_f32 v35, v35
  v_rcp_f32 v36, v36
  v_rcp_f32 v37, v37
  v_rcp_f32 v38, v38
  v_rcp_f32 v39, v39
  v_pk_mul_f32 v[112:113], v[112:113], v[32:33]
  v_pk_mul_f32 v[114:115], v[114:115], v[34:35]
  v_pk_mul_f32 v[116:117], v[116:117], v[36:37]
  v_pk_mul_f32 v[118:119], v[118:119], v[38:39]
  v_pk_mul_f32 v[32:33], v[120:121], v[120:121]
  v_pk_mul_f32 v[34:35], v[122:123], v[122:123]
  v_pk_mul_f32 v[36:37], v[124:125], v[124:125]
  v_pk_mul_f32 v[38:39], v[126:127], v[126:127]
  v_pk_fma_f32 v[32:33], v[32:33], s[68:69], v[30:31]
  v_pk_fma_f32 v[34:35], v[34:35], s[68:69], v[30:31]
  v_pk_fma_f32 v[36:37], v[36:37], s[68:69], v[30:31]
  v_pk_fma_f32 v[38:39], v[38:39], s[68:69], v[30:31]
  v_pk_mul_f32 v[32:33], v[32:33], v[120:121]
  v_pk_mul_f32 v[34:35], v[34:35], v[122:123]
  v_pk_mul_f32 v[36:37], v[36:37], v[124:125]
  v_pk_mul_f32 v[38:39], v[38:39], v[126:127]
  v_exp_f32 v32, v32
  v_exp_f32 v33, v33
  v_exp_f32 v34, v34
  v_exp_f32 v35, v35
  v_exp_f32 v36, v36
  v_exp_f32 v37, v37
  v_exp_f32 v38, v38
  v_exp_f32 v39, v39
  v_pk_add_f32 v[32:33], v[32:33], v[40:41]
  v_pk_add_f32 v[34:35], v[34:35], v[40:41]
  v_pk_add_f32 v[36:37], v[36:37], v[40:41]
  v_pk_add_f32 v[38:39], v[38:39], v[40:41]
  v_rcp_f32 v32, v32
  v_rcp_f32 v33, v33
  v_rcp_f32 v34, v34
  v_rcp_f32 v35, v35
  v_rcp_f32 v36, v36
  v_rcp_f32 v37, v37
  v_rcp_f32 v38, v38
  v_rcp_f32 v39, v39
  v_pk_mul_f32 v[120:121], v[120:121], v[32:33]
  v_pk_mul_f32 v[122:123], v[122:123], v[34:35]
  v_pk_mul_f32 v[124:125], v[124:125], v[36:37]
  v_pk_mul_f32 v[126:127], v[126:127], v[38:39]
  s_cmp_ge_u32 s70, 27
  s_cbranch_scc1 L_k1_5
  s_add_u32 s36, s26, 0x800000
  s_addc_u32 s37, s27, 0
  s_mov_b32 s38, 0x360000
  s_mov_b32 s39, 0x20000
  s_lshl_b32 s72, s70, 17
  v_cvt_pk_bf16_f32 v44, v96, v97
  v_cvt_pk_bf16_f32 v45, v98, v99
  v_cvt_pk_bf16_f32 v46, v100, v101
  v_cvt_pk_bf16_f32 v47, v102, v103
  v_cvt_pk_bf16_f32 v48, v104, v105
  v_cvt_pk_bf16_f32 v49, v106, v107
  v_cvt_pk_bf16_f32 v50, v108, v109
  v_cvt_pk_bf16_f32 v51, v110, v111
  s_add_u32 s73, s72, 65536
  s_nop 0
  v_permlane32_swap_b32 v44, v46
  v_permlane32_swap_b32 v45, v47
  v_permlane32_swap_b32 v48, v50
  v_permlane32_swap_b32 v49, v51
  buffer_store_dwordx4 v[44:47], v17, s[36:39], s72 offen offset:0
  buffer_store_dwordx4 v[48:51], v17, s[36:39], s73 offen offset:0
  v_cvt_pk_bf16_f32 v52, v112, v113
  v_cvt_pk_bf16_f32 v53, v114, v115
  v_cvt_pk_bf16_f32 v54, v116, v117
  v_cvt_pk_bf16_f32 v55, v118, v119
  v_cvt_pk_bf16_f32 v56, v120, v121
  v_cvt_pk_bf16_f32 v57, v122, v123
  v_cvt_pk_bf16_f32 v58, v124, v125
  v_cvt_pk_bf16_f32 v59, v126, v127
  s_add_u32 s73, s72, 65536
  s_nop 0
  v_permlane32_swap_b32 v52, v54
  v_permlane32_swap_b32 v53, v55
  v_permlane32_swap_b32 v56, v58
  v_permlane32_swap_b32 v57, v59
  buffer_store_dwordx4 v[52:55], v17, s[36:39], s72 offen offset:512
  buffer_store_dwordx4 v[56:59], v17, s[36:39], s73 offen offset:512
  s_branch L_k1_fin
L_k1_5:
  s_add_u32 s36, s26, 0x1700000
  s_addc_u32 s37, s27, 0
  s_mov_b32 s38, 0x360000
  s_mov_b32 s39, 0x20000
  s_sub_u32 s71, s70, 27
  s_lshl_b32 s72, s71, 17
  v_cvt_pk_bf16_f32 v44, v96, v97
  v_cvt_pk_bf16_f32 v45, v98, v99
  v_cvt_pk_bf16_f32 v46, v100, v101
  v_cvt_pk_bf16_f32 v47, v102, v103
  v_cvt_pk_bf16_f32 v48, v104, v105
  v_cvt_pk_bf16_f32 v49, v106, v107
  v_cvt_pk_bf16_f32 v50, v108, v109
  v_cvt_pk_bf16_f32 v51, v110, v111
  s_add_u32 s73, s72, 65536
  s_nop 0
  v_permlane32_swap_b32 v44, v46
  v_permlane32_swap_b32 v45, v47
  v_permlane32_swap_b32 v48, v50
  v_permlane32_swap_b32 v49, v51
  buffer_store_dwordx4 v[44:47], v17, s[36:39], s72 offen offset:0
  buffer_store_dwordx4 v[48:51], v17, s[36:39], s73 offen offset:0
  v_cvt_pk_bf16_f32 v52, v112, v113
  v_cvt_pk_bf16_f32 v53, v114, v115
  v_cvt_pk_bf16_f32 v54, v116, v117
  v_cvt_pk_bf16_f32 v55, v118, v119
  v_cvt_pk_bf16_f32 v56, v120, v121
  v_cvt_pk_bf16_f32 v57, v122, v123
  v_cvt_pk_bf16_f32 v58, v124, v125
  v_cvt_pk_bf16_f32 v59, v126, v127
  s_add_u32 s73, s72, 65536
  s_nop 0
  v_permlane32_swap_b32 v52, v54
  v_permlane32_swap_b32 v53, v55
  v_permlane32_swap_b32 v56, v58
  v_permlane32_swap_b32 v57, v59
  buffer_store_dwordx4 v[52:55], v17, s[36:39], s72 offen offset:512
  buffer_store_dwordx4 v[56:59], v17, s[36:39], s73 offen offset:512
  v_add_f32 v22, v96, v97
  v_mul_f32 v23, v96, v96
  v_fmac_f32 v23, v97, v97
  v_add_f32 v22, v22, v98
  v_fmac_f32 v23, v98, v98
  v_add_f32 v22, v22, v99
  v_fmac_f32 v23, v99, v99
  v_add_f32 v22, v22, v100
  v_fmac_f32 v23, v100, v100
  v_add_f32 v22, v22, v101
  v_fmac_f32 v23, v101, v101
  v_add_f32 v22, v22, v102
  v_fmac_f32 v23, v102, v102
  v_add_f32 v22, v22, v103
  v_fmac_f32 v23, v103, v103
  v_add_f32 v22, v22, v104
  v_fmac_f32 v23, v104, v104
  v_add_f32 v22, v22, v105
  v_fmac_f32 v23, v105, v105
  v_add_f32 v22, v22, v106
  v_fmac_f32 v23, v106, v106
  v_add_f32 v22, v22, v107
  v_fmac_f32 v23, v107, v107
  v_add_f32 v22, v22, v108
  v_fmac_f32 v23, v108, v108
  v_add_f32 v22, v22, v109
  v_fmac_f32 v23, v109, v109
  v_add_f32 v22, v22, v110
  v_fmac_f32 v23, v110, v110
  v_add_f32 v22, v22, v111
  v_fmac_f32 v23, v111, v111
  v_add_f32 v24, v112, v113
  v_mul_f32 v25, v112, v112
  v_fmac_f32 v25, v113, v113
  v_add_f32 v24, v24, v114
  v_fmac_f32 v25, v114, v114
  v_add_f32 v24, v24, v115
  v_fmac_f32 v25, v115, v115
  v_add_f32 v24, v24, v116
  v_fmac_f32 v25, v116, v116
  v_add_f32 v24, v24, v117
  v_fmac_f32 v25, v117, v117
  v_add_f32 v24, v24, v118
  v_fmac_f32 v25, v118, v118
  v_add_f32 v24, v24, v119
  v_fmac_f32 v25, v119, v119
  v_add_f32 v24, v24, v120
  v_fmac_f32 v25, v120, v120
  v_add_f32 v24, v24, v121
  v_fmac_f32 v25, v121, v121
  v_add_f32 v24, v24, v122
  v_fmac_f32 v25, v122, v122
  v_add_f32 v24, v24, v123
  v_fmac_f32 v25, v123, v123
  v_add_f32 v24, v24, v124
  v_fmac_f32 v25, v124, v124
  v_add_f32 v24, v24, v125
  v_fmac_f32 v25, v125, v125
  v_add_f32 v24, v24, v126
  v_fmac_f32 v25, v126, v126
  v_add_f32 v24, v24, v127
  v_fmac_f32 v25, v127, v127
  v_mov_b32 v26, v22
  v_mov_b32 v27, v23
  v_mov_b32 v28, v24
  v_mov_b32 v29, v25
  s_nop 1
  v_permlane32_swap_b32 v22, v26
  v_permlane32_swap_b32 v23, v27
  v_permlane32_swap_b32 v24, v28
  v_permlane32_swap_b32 v25, v29
  s_nop 1
  v_add_f32 v22, v22, v26
  v_add_f32 v23, v23, v27
  v_add_f32 v24, v24, v28
  v_add_f32 v25, v25, v29
  s_add_u32 s60, s26, 0x1a80000
  s_addc_u32 s61, s27, 0
  s_mov_b32 s62, 0x6c000
  s_mov_b32 s63, 0x20000
  s_lshl_b32 s72, s71, 14
  v_lshrrev_b32 v26, 1, v16
  s_mov_b32 exec_hi, 0
  buffer_store_dwordx2 v[22:23], v26, s[60:63], s72 offen
  buffer_store_dwordx2 v[24:25], v26, s[60:63], s72 offen offset:256
L_k1_fin:
  s_endpgm
L_k1_gate:
L_k1_misc:
  s_cmp_ge_u32 s40, 8
  s_cbranch_scc1 L_k1_end
  s_waitcnt lgkmcnt(0)
  v_lshlrev_b32 v2, 4, v1
  s_lshl_b32 s61, s40, 10
  s_add_u32 s60, s44, 0
  s_cmp_ge_u32 s60, 47
  s_cbranch_scc1 L_k1_7
  s_cmp_lt_u32 s60, 20
  s_cbranch_scc0 L_k1_8
  s_mov_b32 s28, s8
  s_mov_b32 s29, s9
  s_mov_b32 s30, 0xc8000
  s_mov_b32 s31, 0x20000
  s_mul_i32 s62, s60, 40960
  s_branch L_k1_9
L_k1_8:
  s_mov_b32 s28, s18
  s_mov_b32 s29, s19
  s_mov_b32 s30, 0x10e000
  s_mov_b32 s31, 0x20000
  s_sub_u32 s63, s60, 20
  s_mul_i32 s62, s63, 40960
L_k1_9:
  s_add_u32 s62, s62, s61
  s_sub_u32 s62, s62, 8192
  s_add_u32 m0, s61, 0
  s_add_u32 s62, s62, 8192
  buffer_load_dwordx4 v2, s[28:31], s62 offen lds
  s_add_u32 m0, s61, 8192
  s_add_u32 s62, s62, 8192
  buffer_load_dwordx4 v2, s[28:31], s62 offen lds
  s_add_u32 m0, s61, 16384
  s_add_u32 s62, s62, 8192
  buffer_load_dwordx4 v2, s[28:31], s62 offen lds
  s_add_u32 m0, s61, 24576
  s_add_u32 s62, s62, 8192
  buffer_load_dwordx4 v2, s[28:31], s62 offen lds
  s_add_u32 m0, s61, 32768
  s_add_u32 s62, s62, 8192
  buffer_load_dwordx4 v2, s[28:31], s62 offen lds
L_k1_7:
  s_add_u32 s60, s44, 16
  s_cmp_ge_u32 s60, 47
  s_cbranch_scc1 L_k1_10
  s_cmp_lt_u32 s60, 20
  s_cbranch_scc0 L_k1_11
  s_mov_b32 s28, s8
  s_mov_b32 s29, s9
  s_mov_b32 s30, 0xc8000
  s_mov_b32 s31, 0x20000
  s_mul_i32 s62, s60, 40960
  s_branch L_k1_12
L_k1_11:
  s_mov_b32 s28, s18
  s_mov_b32 s29, s19
  s_mov_b32 s30, 0x10e000
  s_mov_b32 s31, 0x20000
  s_sub_u32 s63, s60, 20
  s_mul_i32 s62, s63, 40960
L_k1_12:
  s_add_u32 s62, s62, s61
  s_sub_u32 s62, s62, 8192
  s_add_u32 m0, s61, 40960
  s_add_u32 s62, s62, 8192
  buffer_load_dwordx4 v2, s[28:31], s62 offen lds
  s_add_u32 m0, s61, 49152
  s_add_u32 s62, s62, 8192
  buffer_load_dwordx4 v2, s[28:31], s62 offen lds
  s_add_u32 m0, s61, 57344
  s_add_u32 s62, s62, 8192
  buffer_load_dwordx4 v2, s[28:31], s62 offen lds
  s_add_u32 m0, s61, 65536
  s_add_u32 s62, s62, 8192
  buffer_load_dwordx4 v2, s[28:31], s62 offen lds
  s_add_u32 m0, s61, 73728
  s_add_u32 s62, s62, 8192
  buffer_load_dwordx4 v2, s[28:31], s62 offen lds
L_k1_10:
  s_add_u32 s60, s44, 32
  s_cmp_ge_u32 s60, 47
  s_cbranch_scc1 L_k1_13
  s_cmp_lt_u32 s60, 20
  s_cbranch_scc0 L_k1_14
  s_mov_b32 s28, s8
  s_mov_b32 s29, s9
  s_mov_b32 s30, 0xc8000
  s_mov_b32 s31, 0x20000
  s_mul_i32 s62, s60, 40960
  s_branch L_k1_15
L_k1_14:
  s_mov_b32 s28, s18
  s_mov_b32 s29, s19
  s_mov_b32 s30, 0x10e000
  s_mov_b32 s31, 0x20000
  s_sub_u32 s63, s60, 20
  s_mul_i32 s62, s63, 40960
L_k1_15:
  s_add_u32 s62, s62, s61
  s_sub_u32 s62, s62, 8192
  s_add_u32 m0, s61, 81920
  s_add_u32 s62, s62, 8192
  buffer_load_dwordx4 v2, s[28:31], s62 offen lds
  s_add_u32 m0, s61, 90112
  s_add_u32 s62, s62, 8192
  buffer_load_dwordx4 v2, s[28:31], s62 offen lds
  s_add_u32 m0, s61, 98304
  s_add_u32 s62, s62, 8192
  buffer_load_dwordx4 v2, s[28:31], s62 offen lds
  s_add_u32 m0, s61, 106496
  s_add_u32 s62, s62, 8192
  buffer_load_dwordx4 v2, s[28:31], s62 offen lds
  s_add_u32 m0, s61, 114688
  s_add_u32 s62, s62, 8192
  buffer_load_dwordx4 v2, s[28:31], s62 offen lds
L_k1_13:
  s_cmp_lg_u32 s44, 0
  s_cbranch_scc1 L_k1_16
  s_add_u32 s36, s26, 0x1b00000
  s_addc_u32 s37, s27, 0
  s_mov_b32 s38, 0xa000
  s_mov_b32 s39, 0x20000
  v_lshlrev_b32 v3, 4, v1
  s_lshl_b32 s62, s40, 10
  v_mov_b32 v4, 0
  v_mov_b32 v5, 0
  v_mov_b32 v6, 0
  v_mov_b32 v7, 0
  buffer_store_dwordx4 v[4:7], v3, s[36:39], s62 offen
  s_add_u32 s62, s62, 8192
  buffer_store_dwordx4 v[4:7], v3, s[36:39], s62 offen
  s_add_u32 s62, s62, 8192
  buffer_store_dwordx4 v[4:7], v3, s[36:39], s62 offen
  s_add_u32 s62, s62, 8192
  buffer_store_dwordx4 v[4:7], v3, s[36:39], s62 offen
  s_add_u32 s62, s62, 8192
  buffer_store_dwordx4 v[4:7], v3, s[36:39], s62 offen
  s_add_u32 s62, s62, 8192
  s_nop 1
L_k1_16:
  s_mov_b32 s36, s4
  s_mov_b32 s37, s5
  s_mov_b32 s38, 0x280000
  s_mov_b32 s39, 0x20000
  s_mov_b32 s64, s20
  s_mov_b32 s65, s21
  s_mov_b32 s66, 0x500
  s_mov_b32 s67, 0x20000
  s_add_u32 s68, s26, 0xec0000
  s_addc_u32 s69, s27, 0
  s_mov_b32 s70, 0x2000
  s_mov_b32 s71, 0x20000
  v_lshrrev_b32 v3, 4, v1
  v_and_b32 v4, 15, v1
  v_mul_u32_u24 v5, 80, v4
  buffer_load_dwordx4 v[8:11], v5, s[64:67], 0 offen offset:0
  buffer_load_dwordx4 v[12:15], v5, s[64:67], 0 offen offset:16
  buffer_load_dwordx4 v[16:19], v5, s[64:67], 0 offen offset:32
  buffer_load_dwordx4 v[20:23], v5, s[64:67], 0 offen offset:48
  buffer_load_dwordx4 v[24:27], v5, s[64:67], 0 offen offset:64
  s_lshl_b32 s62, s44, 7
  s_lshl_b32 s63, s40, 4
  s_add_u32 s62, s62, s63
  v_add_u32 v6, s62, v3
  v_mul_u32_u24 v7, 1280, v6
  v_add_u32 v7, v7, v5
  v_lshlrev_b32 v6, 2, v6
  s_mov_b32 s63, 0
  buffer_load_dwordx4 v[28:31], v7, s[36:39], s63 offen offset:0
  buffer_load_dwordx4 v[32:35], v7, s[36:39], s63 offen offset:16
  buffer_load_dwordx4 v[36:39], v7, s[36:39], s63 offen offset:32
  buffer_load_dwordx4 v[40:43], v7, s[36:39], s63 offen offset:48
  buffer_load_dwordx4 v[44:47], v7, s[36:39], s63 offen offset:64
  s_mov_b32 s63, 5120
  buffer_load_dwordx4 v[48:51], v7, s[36:39], s63 offen offset:0
  buffer_load_dwordx4 v[52:55], v7, s[36:39], s63 offen offset:16
  buffer_load_dwordx4 v[56:59], v7, s[36:39], s63 offen offset:32
  buffer_load_dwordx4 v[60:63], v7, s[36:39], s63 offen offset:48
  buffer_load_dwordx4 v[64:67], v7, s[36:39], s63 offen offset:64
  s_mov_b32 s63, 10240
  buffer_load_dwordx4 v[68:71], v7, s[36:39], s63 offen offset:0
  buffer_load_dwordx4 v[72:75], v7, s[36:39], s63 offen offset:16
  buffer_load_dwordx4 v[76:79], v7, s[36:39], s63 offen offset:32
  buffer_load_dwordx4 v[80:83], v7, s[36:39], s63 offen offset:48
  buffer_load_dwordx4 v[84:87], v7, s[36:39], s63 offen offset:64
  s_mov_b32 s63, 15360
  buffer_load_dwordx4 v[88:91], v7, s[36:39], s63 offen offset:0
  buffer_load_dwordx4 v[92:95], v7, s[36:39], s63 offen offset:16
  buffer_load_dwordx4 v[96:99], v7, s[36:39], s63 offen offset:32
  buffer_load_dwordx4 v[100:103], v7, s[36:39], s63 offen offset:48
  buffer_load_dwordx4 v[104:107], v7, s[36:39], s63 offen offset:64
  s_waitcnt vmcnt(0)
  v_mov_b32 v110, 0
  v_mov_b32 v111, 0
  v_mov_b32 v112, 0
  v_mov_b32 v113, 0
  v_dot2c_f32_bf16 v110, v8, v28
  v_dot2c_f32_bf16 v111, v8, v48
  v_dot2c_f32_bf16 v112, v8, v68
  v_dot2c_f32_bf16 v113, v8, v88
  v_dot2c_f32_bf16 v110, v9, v29
  v_dot2c_f32_bf16 v111, v9, v49
  v_dot2c_f32_bf16 v112, v9, v69
  v_dot2c_f32_bf16 v113, v9, v89
  v_dot2c_f32_bf16 v110, v10, v30
  v_dot2c_f32_bf16 v111, v10, v50
  v_dot2c_f32_bf16 v112, v10, v70
  v_dot2c_f32_bf16 v113, v10, v90
  v_dot2c_f32_bf16 v110, v11, v31
  v_dot2c_f32_bf16 v111, v11, v51
  v_dot2c_f32_bf16 v112, v11, v71
  v_dot2c_f32_bf16 v113, v11, v91
  v_dot2c_f32_bf16 v110, v12, v32
  v_dot2c_f32_bf16 v111, v12, v52
  v_dot2c_f32_bf16 v112, v12, v72
  v_dot2c_f32_bf16 v113, v12, v92
  v_dot2c_f32_bf16 v110, v13, v33
  v_dot2c_f32_bf16 v111, v13, v53
  v_dot2c_f32_bf16 v112, v13, v73
  v_dot2c_f32_bf16 v113, v13, v93
  v_dot2c_f32_bf16 v110, v14, v34
  v_dot2c_f32_bf16 v111, v14, v54
  v_dot2c_f32_bf16 v112, v14, v74
  v_dot2c_f32_bf16 v113, v14, v94
  v_dot2c_f32_bf16 v110, v15, v35
  v_dot2c_f32_bf16 v111, v15, v55
  v_dot2c_f32_bf16 v112, v15, v75
  v_dot2c_f32_bf16 v113, v15, v95
  v_dot2c_f32_bf16 v110, v16, v36
  v_dot2c_f32_bf16 v111, v16, v56
  v_dot2c_f32_bf16 v112, v16, v76
  v_dot2c_f32_bf16 v113, v16, v96
  v_dot2c_f32_bf16 v110, v17, v37
  v_dot2c_f32_bf16 v111, v17, v57
  v_dot2c_f32_bf16 v112, v17, v77
  v_dot2c_f32_bf16 v113, v17, v97
  v_dot2c_f32_bf16 v110, v18, v38
  v_dot2c_f32_bf16 v111, v18, v58
  v_dot2c_f32_bf16 v112, v18, v78
  v_dot2c_f32_bf16 v113, v18, v98
  v_dot2c_f32_bf16 v110, v19, v39
  v_dot2c_f32_bf16 v111, v19, v59
  v_dot2c_f32_bf16 v112, v19, v79
  v_dot2c_f32_bf16 v113, v19, v99
  v_dot2c_f32_bf16 v110, v20, v40
  v_dot2c_f32_bf16 v111, v20, v60
  v_dot2c_f32_bf16 v112, v20, v80
  v_dot2c_f32_bf16 v113, v20, v100
  v_dot2c_f32_bf16 v110, v21, v41
  v_dot2c_f32_bf16 v111, v21, v61
  v_dot2c_f32_bf16 v112, v21, v81
  v_dot2c_f32_bf16 v113, v21, v101
  v_dot2c_f32_bf16 v110, v22, v42
  v_dot2c_f32_bf16 v111, v22, v62
  v_dot2c_f32_bf16 v112, v22, v82
  v_dot2c_f32_bf16 v113, v22, v102
  v_dot2c_f32_bf16 v110, v23, v43
  v_dot2c_f32_bf16 v111, v23, v63
  v_dot2c_f32_bf16 v112, v23, v83
  v_dot2c_f32_bf16 v113, v23, v103
  v_dot2c_f32_bf16 v110, v24, v44
  v_dot2c_f32_bf16 v111, v24, v64
  v_dot2c_f32_bf16 v112, v24, v84
  v_dot2c_f32_bf16 v113, v24, v104
  v_dot2c_f32_bf16 v110, v25, v45
  v_dot2c_f32_bf16 v111, v25, v65
  v_dot2c_f32_bf16 v112, v25, v85
  v_dot2c_f32_bf16 v113, v25, v105
  v_dot2c_f32_bf16 v110, v26, v46
  v_dot2c_f32_bf16 v111, v26, v66
  v_dot2c_f32_bf16 v112, v26, v86
  v_dot2c_f32_bf16 v113, v26, v106
  v_dot2c_f32_bf16 v110, v27, v47
  v_dot2c_f32_bf16 v111, v27, v67
  v_dot2c_f32_bf16 v112, v27, v87
  v_dot2c_f32_bf16 v113, v27, v107
  s_nop 1
  v_add_f32 v110, v110, v110 row_ror:8
  v_add_f32 v111, v111, v111 row_ror:8
  v_add_f32 v112, v112, v112 row_ror:8
  v_add_f32 v113, v113, v113 row_ror:8
  s_nop 1
  v_add_f32 v110, v110, v110 row_ror:4
  v_add_f32 v111, v111, v111 row_ror:4
  v_add_f32 v112, v112, v112 row_ror:4
  v_add_f32 v113, v113, v113 row_ror:4
  s_nop 1
  v_add_f32 v110, v110, v110 row_ror:2
  v_add_f32 v111, v111, v111 row_ror:2
  v_add_f32 v112, v112, v112 row_ror:2
  v_add_f32 v113, v113, v113 row_ror:2
  s_nop 1
  v_add_f32 v110, v110, v110 row_ror:1
  v_add_f32 v111, v111, v111 row_ror:1
  v_add_f32 v112, v112, v112 row_ror:1
  v_add_f32 v113, v113, v113 row_ror:1
  s_nop 1
  s_mov_b32 s63, 0xbfb8aa3b
  v_mul_f32 v110, s63, v110
  v_mul_f32 v111, s63, v111
  v_mul_f32 v112, s63, v112
  v_mul_f32 v113, s63, v113
  v_exp_f32 v110, v110
  v_exp_f32 v111, v111
  v_exp_f32 v112, v112
  v_exp_f32 v113, v113
  s_nop 0
  v_add_f32 v110, 1.0, v110
  v_add_f32 v111, 1.0, v111
  v_add_f32 v112, 1.0, v112
  v_add_f32 v113, 1.0, v113
  v_rcp_f32 v110, v110
  v_rcp_f32 v111, v111
  v_rcp_f32 v112, v112
  v_rcp_f32 v113, v113
  v_cmp_eq_u32 vcc, 0, v4
  s_and_saveexec_b64 s[72:73], vcc
  buffer_store_dword v110, v6, s[68:71], 0 offen offset:0
  buffer_store_dword v111, v6, s[68:71], 0 offen offset:16
  buffer_store_dword v112, v6, s[68:71], 0 offen offset:32
  buffer_store_dword v113, v6, s[68:71], 0 offen offset:48
  s_mov_b64 exec, s[72:73]
  s_add_u32 s36, s26, 0x14c0000
  s_addc_u32 s37, s27, 0
  s_mov_b32 s38, 0x1d6000
  s_mov_b32 s39, 0x20000
  v_lshrrev_b32 v5, 2, v4
  v_lshl_add_u32 v5, v3, 3, v5
  v_mul_u32_u24 v5, 1280, v5
  v_and_b32 v6, 3, v1
  v_lshl_add_u32 v5, v6, 3, v5
  s_mul_i32 s62, s40, 160
  v_add_u32 v5, s62, v5
  v_mul_u32_u24 v6, 640, v3
  v_add_u32 v6, v6, v4
  v_lshlrev_b32 v6, 4, v6
  s_mul_i32 s62, s40, 1280
  v_add_u32 v6, s62, v6
  s_waitcnt vmcnt(0)
  s_barrier
  s_add_u32 s60, s44, 0
  s_cmp_ge_u32 s60, 47
  s_cbranch_scc1 L_k1_17
  s_mul_i32 s62, s60, 40960
  ds_read_b64_tr_b16 v[8:9], v5 offset:0
  ds_read_b64_tr_b16 v[10:11], v5 offset:5120
  ds_read_b64_tr_b16 v[12:13], v5 offset:32
  ds_read_b64_tr_b16 v[14:15], v5 offset:5152
  ds_read_b64_tr_b16 v[16:17], v5 offset:64
  ds_read_b64_tr_b16 v[18:19], v5 offset:5184
  ds_read_b64_tr_b16 v[20:21], v5 offset:96
  ds_read_b64_tr_b16 v[22:23], v5 offset:5216
  ds_read_b64_tr_b16 v[24:25], v5 offset:128
  ds_read_b64_tr_b16 v[26:27], v5 offset:5248
  s_waitcnt lgkmcnt(0)
  buffer_store_dwordx4 v[8:11], v6, s[36:39], s62 offen offset:0
  buffer_store_dwordx4 v[12:15], v6, s[36:39], s62 offen offset:256
  buffer_store_dwordx4 v[16:19], v6, s[36:39], s62 offen offset:512
  buffer_store_dwordx4 v[20:23], v6, s[36:39], s62 offen offset:768
  buffer_store_dwordx4 v[24:27], v6, s[36:39], s62 offen offset:1024
L_k1_17:
  v_add_u32 v5, 40960, v5
  s_add_u32 s60, s44, 16
  s_cmp_ge_u32 s60, 47
  s_cbranch_scc1 L_k1_18
  s_mul_i32 s62, s60, 40960
  ds_read_b64_tr_b16 v[28:29], v5 offset:0
  ds_read_b64_tr_b16 v[30:31], v5 offset:5120
  ds_read_b64_tr_b16 v[32:33], v5 offset:32
  ds_read_b64_tr_b16 v[34:35], v5 offset:5152
  ds_read_b64_tr_b16 v[36:37], v5 offset:64
  ds_read_b64_tr_b16 v[38:39], v5 offset:5184
  ds_read_b64_tr_b16 v[40:41], v5 offset:96
  ds_read_b64_tr_b16 v[42:43], v5 offset:5216
  ds_read_b64_tr_b16 v[44:45], v5 offset:128
  ds_read_b64_tr_b16 v[46:47], v5 offset:5248
  s_waitcnt lgkmcnt(0)
  buffer_store_dwordx4 v[28:31], v6, s[36:39], s62 offen offset:0
  buffer_store_dwordx4 v[32:35], v6, s[36:39], s62 offen offset:256
  buffer_store_dwordx4 v[36:39], v6, s[36:39], s62 offen offset:512
  buffer_store_dwordx4 v[40:43], v6, s[36:39], s62 offen offset:768
  buffer_store_dwordx4 v[44:47], v6, s[36:39], s62 offen offset:1024
L_k1_18:
  v_add_u32 v5, 40960, v5
  s_add_u32 s60, s44, 32
  s_cmp_ge_u32 s60, 47
  s_cbranch_scc1 L_k1_19
  s_mul_i32 s62, s60, 40960
  ds_read_b64_tr_b16 v[48:49], v5 offset:0
  ds_read_b64_tr_b16 v[50:51], v5 offset:5120
  ds_read_b64_tr_b16 v[52:53], v5 offset:32
  ds_read_b64_tr_b16 v[54:55], v5 offset:5152
  ds_read_b64_tr_b16 v[56:57], v5 offset:64
  ds_read_b64_tr_b16 v[58:59], v5 offset:5184
  ds_read_b64_tr_b16 v[60:61], v5 offset:96
  ds_read_b64_tr_b16 v[62:63], v5 offset:5216
  ds_read_b64_tr_b16 v[64:65], v5 offset:128
  ds_read_b64_tr_b16 v[66:67], v5 offset:5248
  s_waitcnt lgkmcnt(0)
  buffer_store_dwordx4 v[48:51], v6, s[36:39], s62 offen offset:0
  buffer_store_dwordx4 v[52:55], v6, s[36:39], s62 offen offset:256
  buffer_store_dwordx4 v[56:59], v6, s[36:39], s62 offen offset:512
  buffer_store_dwordx4 v[60:63], v6, s[36:39], s62 offen offset:768
  buffer_store_dwordx4 v[64:67], v6, s[36:39], s62 offen offset:1024
L_k1_19:
  v_add_u32 v5, 40960, v5
L_k1_end:
  s_endpgm
L_k1_prod:
  s_sub_u32 s43, s40, 8
  v_lshrrev_b32 v17, 4, v1
  v_and_b32 v18, 15, v1
  v_lshrrev_b32 v20, 3, v1
  v_mul_u32_u24 v20, 1280, v20
  s_and_b32 s62, s43, 1
  s_lshl_b32 s62, s62, 2
  v_add_u32 v21, s62, v17
  v_and_b32 v21, 7, v21
  v_and_b32 v22, 7, v1
  v_xor_b32 v21, v21, v22
  v_lshl_add_u32 v8, v21, 4, v20
  s_lshl_b32 s62, s44, 7
  s_lshl_b32 s63, s43, 3
  s_add_u32 s62, s62, s63
  s_mul_i32 s46, s62, 1280
  s_sub_u32 s46, s46, 128
  s_add_u32 s47, s46, 40960
  s_add_u32 s48, s47, 40960
  s_add_u32 s49, s48, 40960
  v_lshlrev_b32 v19, 2, v17
  v_xor_b32 v19, v19, v18
  v_lshlrev_b32 v19, 4, v19
  s_lshl_b32 s62, s45, 8
  v_add_u32 v19, s62, v19
  v_mul_u32_u24 v24, 3840, v17
  v_add_u32 v9, v19, v24
  v_mul_u32_u24 v24, 3456, v17
  v_add_u32 v10, v19, v24
  s_mul_i32 s50, s43, 15360
  s_sub_u32 s50, s50, 245760
  s_add_u32 s51, s50, 61440
  s_add_u32 s52, s51, 61440
  s_add_u32 s53, s52, 61440
  s_mul_i32 s64, s43, 13824
  s_sub_u32 s64, s64, 221184
  s_add_u32 s65, s64, 55296
  s_add_u32 s66, s65, 55296
  s_add_u32 s67, s66, 55296
  s_cmp_eq_u32 s45, 15
  s_cselect_b32 s50, 0x7f000000, s50
  s_cselect_b32 s51, 0x7f000000, s51
  s_cselect_b32 s52, 0x7f000000, s52
  s_cselect_b32 s53, 0x7f000000, s53
  s_cmp_ge_u32 s45, 14
  s_cselect_b32 s64, 0x7f000000, s64
  s_cselect_b32 s65, 0x7f000000, s65
  s_cselect_b32 s66, 0x7f000000, s66
  s_cselect_b32 s67, 0x7f000000, s67
  s_lshl_b32 s54, s43, 10
  s_waitcnt lgkmcnt(0)
  s_mov_b32 s28, s4
  s_mov_b32 s29, s5
  s_mov_b32 s30, 0x280000
  s_mov_b32 s31, 0x20000
  s_mov_b32 s32, s6
  s_mov_b32 s33, s7
  s_mov_b32 s34, 0x258000
  s_mov_b32 s35, 0x20000
  s_mov_b32 s36, s12
  s_mov_b32 s37, s13
  s_mov_b32 s38, 0x21c000
  s_mov_b32 s39, 0x20000
  s_add_u32 s60, s54, 0
  s_add_u32 m0, s60, 0
  s_add_u32 s46, s46, 128
  buffer_load_dwordx4 v8, s[28:31], s46 offen lds
  s_add_u32 s60, s54, 0
  s_add_u32 m0, s60, 4096
  s_add_u32 s47, s47, 128
  buffer_load_dwordx4 v8, s[28:31], s47 offen lds
  s_add_u32 s60, s54, 0
  s_add_u32 m0, s60, 8192
  s_add_u32 s48, s48, 128
  buffer_load_dwordx4 v8, s[28:31], s48 offen lds
  s_add_u32 s60, s54, 0
  s_add_u32 m0, s60, 12288
  s_add_u32 s49, s49, 128
  buffer_load_dwordx4 v8, s[28:31], s49 offen lds
  s_add_u32 s60, s54, 0
  s_add_u32 m0, s60, 16384
  s_add_u32 s50, s50, 245760
  buffer_load_dwordx4 v9, s[32:35], s50 offen lds
  s_add_u32 s60, s54, 0
  s_add_u32 m0, s60, 20480
  s_add_u32 s51, s51, 245760
  buffer_load_dwordx4 v9, s[32:35], s51 offen lds
  s_add_u32 s60, s54, 0
  s_add_u32 m0, s60, 24576
  s_add_u32 s52, s52, 245760
  buffer_load_dwordx4 v9, s[32:35], s52 offen lds
  s_add_u32 s60, s54, 0
  s_add_u32 m0, s60, 28672
  s_add_u32 s53, s53, 245760
  buffer_load_dwordx4 v9, s[32:35], s53 offen lds
  s_add_u32 s60, s54, 0
  s_add_u32 m0, s60, 32768
  s_add_u32 s64, s64, 221184
  buffer_load_dwordx4 v10, s[36:39], s64 offen lds
  s_add_u32 s60, s54, 0
  s_add_u32 m0, s60, 36864
  s_add_u32 s65, s65, 221184
  buffer_load_dwordx4 v10, s[36:39], s65 offen lds
  s_add_u32 s60, s54, 0
  s_add_u32 m0, s60, 40960
  s_add_u32 s66, s66, 221184
  buffer_load_dwordx4 v10, s[36:39], s66 offen lds
  s_add_u32 s60, s54, 0
  s_add_u32 m0, s60, 45056
  s_add_u32 s67, s67, 221184
  buffer_load_dwordx4 v10, s[36:39], s67 offen lds
  s_add_u32 s60, s54, 49152
  s_add_u32 m0, s60, 0
  s_add_u32 s46, s46, 128
  buffer_load_dwordx4 v8, s[28:31], s46 offen lds
  s_add_u32 s60, s54, 49152
  s_add_u32 m0, s60, 4096
  s_add_u32 s47, s47, 128
  buffer_load_dwordx4 v8, s[28:31], s47 offen lds
  s_add_u32 s60, s54, 49152
  s_add_u32 m0, s60, 8192
  s_add_u32 s48, s48, 128
  buffer_load_dwordx4 v8, s[28:31], s48 offen lds
  s_add_u32 s60, s54, 49152
  s_add_u32 m0, s60, 12288
  s_add_u32 s49, s49, 128
  buffer_load_dwordx4 v8, s[28:31], s49 offen lds
  s_add_u32 s60, s54, 49152
  s_add_u32 m0, s60, 16384
  s_add_u32 s50, s50, 245760
  buffer_load_dwordx4 v9, s[32:35], s50 offen lds
  s_add_u32 s60, s54, 49152
  s_add_u32 m0, s60, 20480
  s_add_u32 s51, s51, 245760
  buffer_load_dwordx4 v9, s[32:35], s51 offen lds
  s_add_u32 s60, s54, 49152
  s_add_u32 m0, s60, 24576
  s_add_u32 s52, s52, 245760
  buffer_load_dwordx4 v9, s[32:35], s52 offen lds
  s_add_u32 s60, s54, 49152
  s_add_u32 m0, s60, 28672
  s_add_u32 s53, s53, 245760
  buffer_load_dwordx4 v9, s[32:35], s53 offen lds
  s_add_u32 s60, s54, 49152
  s_add_u32 m0, s60, 32768
  s_add_u32 s64, s64, 221184
  buffer_load_dwordx4 v10, s[36:39], s64 offen lds
  s_add_u32 s60, s54, 49152
  s_add_u32 m0, s60, 36864
  s_add_u32 s65, s65, 221184
  buffer_load_dwordx4 v10, s[36:39], s65 offen lds
  s_add_u32 s60, s54, 49152
  s_add_u32 m0, s60, 40960
  s_add_u32 s66, s66, 221184
  buffer_load_dwordx4 v10, s[36:39], s66 offen lds
  s_add_u32 s60, s54, 49152
  s_add_u32 m0, s60, 45056
  s_add_u32 s67, s67, 221184
  buffer_load_dwordx4 v10, s[36:39], s67 offen lds
  s_add_u32 s60, s54, 98304
  s_add_u32 m0, s60, 0
  s_add_u32 s46, s46, 128
  buffer_load_dwordx4 v8, s[28:31], s46 offen lds
  s_add_u32 s60, s54, 98304
  s_add_u32 m0, s60, 4096
  s_add_u32 s47, s47, 128
  buffer_load_dwordx4 v8, s[28:31], s47 offen lds
  s_add_u32 s60, s54, 98304
  s_add_u32 m0, s60, 8192
  s_add_u32 s48, s48, 128
  buffer_load_dwordx4 v8, s[28:31], s48 offen lds
  s_add_u32 s60, s54, 98304
  s_add_u32 m0, s60, 12288
  s_add_u32 s49, s49, 128
  buffer_load_dwordx4 v8, s[28:31], s49 offen lds
  s_add_u32 s60, s54, 98304
  s_add_u32 m0, s60, 16384
  s_add_u32 s50, s50, 245760
  buffer_load_dwordx4 v9, s[32:35], s50 offen lds
  s_add_u32 s60, s54, 98304
  s_add_u32 m0, s60, 20480
  s_add_u32 s51, s51, 245760
  buffer_load_dwordx4 v9, s[32:35], s51 offen lds
  s_add_u32 s60, s54, 98304
  s_add_u32 m0, s60, 24576
  s_add_u32 s52, s52, 245760
  buffer_load_dwordx4 v9, s[32:35], s52 offen lds
  s_add_u32 s60, s54, 98304
  s_add_u32 m0, s60, 28672
  s_add_u32 s53, s53, 245760
  buffer_load_dwordx4 v9, s[32:35], s53 offen lds
  s_add_u32 s60, s54, 98304
  s_add_u32 m0, s60, 32768
  s_add_u32 s64, s64, 221184
  buffer_load_dwordx4 v10, s[36:39], s64 offen lds
  s_add_u32 s60, s54, 98304
  s_add_u32 m0, s60, 36864
  s_add_u32 s65, s65, 221184
  buffer_load_dwordx4 v10, s[36:39], s65 offen lds
  s_add_u32 s60, s54, 98304
  s_add_u32 m0, s60, 40960
  s_add_u32 s66, s66, 221184
  buffer_load_dwordx4 v10, s[36:39], s66 offen lds
  s_add_u32 s60, s54, 98304
  s_add_u32 m0, s60, 45056
  s_add_u32 s67, s67, 221184
  buffer_load_dwordx4 v10, s[36:39], s67 offen lds
  s_waitcnt vmcnt(24)
  s_barrier
  s_mov_b32 s57, 0
  s_mov_b32 s55, 0
L_k1_20:
  s_cmp_eq_u32 s57, 8
  s_cbranch_scc1 L_k1_21
  s_waitcnt vmcnt(12)
  s_branch L_k1_22
L_k1_21:
  s_waitcnt vmcnt(0)
L_k1_22:
  s_barrier
  s_cmp_ge_u32 s57, 7
  s_cbranch_scc1 L_k1_23
  s_add_u32 s60, s54, s55
  s_add_u32 m0, s60, 0
  s_add_u32 s46, s46, 128
  buffer_load_dwordx4 v8, s[28:31], s46 offen lds
  s_add_u32 s60, s54, s55
  s_add_u32 m0, s60, 4096
  s_add_u32 s47, s47, 128
  buffer_load_dwordx4 v8, s[28:31], s47 offen lds
  s_add_u32 s60, s54, s55
  s_add_u32 m0, s60, 8192
  s_add_u32 s48, s48, 128
  buffer_load_dwordx4 v8, s[28:31], s48 offen lds
  s_add_u32 s60, s54, s55
  s_add_u32 m0, s60, 12288
  s_add_u32 s49, s49, 128
  buffer_load_dwordx4 v8, s[28:31], s49 offen lds
  s_add_u32 s60, s54, s55
  s_add_u32 m0, s60, 16384
  s_add_u32 s50, s50, 245760
  buffer_load_dwordx4 v9, s[32:35], s50 offen lds
  s_add_u32 s60, s54, s55
  s_add_u32 m0, s60, 20480
  s_add_u32 s51, s51, 245760
  buffer_load_dwordx4 v9, s[32:35], s51 offen lds
  s_add_u32 s60, s54, s55
  s_add_u32 m0, s60, 24576
  s_add_u32 s52, s52, 245760
  buffer_load_dwordx4 v9, s[32:35], s52 offen lds
  s_add_u32 s60, s54, s55
  s_add_u32 m0, s60, 28672
  s_add_u32 s53, s53, 245760
  buffer_load_dwordx4 v9, s[32:35], s53 offen lds
  s_add_u32 s60, s54, s55
  s_add_u32 m0, s60, 32768
  s_add_u32 s64, s64, 221184
  buffer_load_dwordx4 v10, s[36:39], s64 offen lds
  s_add_u32 s60, s54, s55
  s_add_u32 m0, s60, 36864
  s_add_u32 s65, s65, 221184
  buffer_load_dwordx4 v10, s[36:39], s65 offen lds
  s_add_u32 s60, s54, s55
  s_add_u32 m0, s60, 40960
  s_add_u32 s66, s66, 221184
  buffer_load_dwordx4 v10, s[36:39], s66 offen lds
  s_add_u32 s60, s54, s55
  s_add_u32 m0, s60, 45056
  s_add_u32 s67, s67, 221184
  buffer_load_dwordx4 v10, s[36:39], s67 offen lds
L_k1_23:
  s_add_u32 s55, s55, 49152
  s_cmp_eq_u32 s55, 147456
  s_cselect_b32 s55, 0, s55
  s_add_u32 s57, s57, 1
  s_cmp_lt_u32 s57, 9
  s_cbranch_scc1 L_k1_20
  s_endpgm
L_k1_pf:
  v_bfe_u32 v6, v1, 2, 3
  v_lshlrev_b32 v6, 3, v6
  s_and_b32 s62, s44, 7
  v_add_u32 v6, s62, v6
  v_and_b32 v8, 3, v1
  v_lshlrev_b32 v8, 7, v8
  v_min_u32 v8, 252, v8
  s_lshl_b32 s62, s45, 8
  v_add_u32 v8, s62, v8
  v_mul_u32_u24 v5, 3840, v6
  v_add_u32 v5, v5, v8
  v_mul_u32_u24 v6, 3456, v6
  v_add_u32 v6, v6, v8
  v_and_b32 v9, 31, v1
  s_lshl_b32 s62, s44, 7
  s_and_b32 s63, s45, 3
  s_lshl_b32 s63, s63, 5
  s_add_u32 s62, s62, s63
  v_add_u32 v9, s62, v9
  v_mul_u32_u24 v9, 1280, v9
  s_waitcnt lgkmcnt(0)
  s_mov_b32 s28, s4
  s_mov_b32 s29, s5
  s_mov_b32 s30, 0x280000
  s_mov_b32 s31, 0x20000
  s_mov_b32 s32, s6
  s_mov_b32 s33, s7
  s_mov_b32 s34, 0x258000
  s_mov_b32 s35, 0x20000
  s_mov_b32 s36, s12
  s_mov_b32 s37, s13
  s_mov_b32 s38, 0x21c000
  s_mov_b32 s39, 0x20000
  s_mov_b32 exec_hi, 0
  s_mov_b32 s62, 737280
  buffer_load_dword v16, v5, s[32:35], s62 offen
  s_mov_b32 s62, 663552
  buffer_load_dword v17, v6, s[36:39], s62 offen
  s_mov_b32 s62, 384
  buffer_load_dword v18, v9, s[28:31], s62 offen
  s_mov_b32 exec_hi, -1
  s_mov_b32 exec_hi, 0
  s_mov_b32 s62, 983040
  buffer_load_dword v16, v5, s[32:35], s62 offen
  s_mov_b32 s62, 884736
  buffer_load_dword v17, v6, s[36:39], s62 offen
  s_mov_b32 s62, 512
  buffer_load_dword v18, v9, s[28:31], s62 offen
  s_mov_b32 exec_hi, -1
  s_barrier
  s_mov_b32 exec_hi, 0
  s_mov_b32 s62, 1228800
  buffer_load_dword v16, v5, s[32:35], s62 offen
  s_mov_b32 s62, 1105920
  buffer_load_dword v17, v6, s[36:39], s62 offen
  s_mov_b32 s62, 640
  buffer_load_dword v18, v9, s[28:31], s62 offen
  s_mov_b32 exec_hi, -1
  s_barrier
  s_mov_b32 exec_hi, 0
  s_mov_b32 s62, 1474560
  buffer_load_dword v16, v5, s[32:35], s62 offen
  s_mov_b32 s62, 1327104
  buffer_load_dword v17, v6, s[36:39], s62 offen
  s_mov_b32 s62, 768
  buffer_load_dword v18, v9, s[28:31], s62 offen
  s_mov_b32 exec_hi, -1
  s_barrier
  s_mov_b32 exec_hi, 0
  s_mov_b32 s62, 1720320
  buffer_load_dword v16, v5, s[32:35], s62 offen
  s_mov_b32 s62, 1548288
  buffer_load_dword v17, v6, s[36:39], s62 offen
  s_mov_b32 s62, 896
  buffer_load_dword v18, v9, s[28:31], s62 offen
  s_mov_b32 exec_hi, -1
  s_barrier
  s_mov_b32 exec_hi, 0
  s_mov_b32 s62, 1966080
  buffer_load_dword v16, v5, s[32:35], s62 offen
  s_mov_b32 s62, 1769472
  buffer_load_dword v17, v6, s[36:39], s62 offen
  s_mov_b32 s62, 1024
  buffer_load_dword v18, v9, s[28:31], s62 offen
  s_mov_b32 exec_hi, -1
  s_barrier
  s_mov_b32 exec_hi, 0
  s_mov_b32 s62, 2211840
  buffer_load_dword v16, v5, s[32:35], s62 offen
  s_mov_b32 s62, 1990656
  buffer_load_dword v17, v6, s[36:39], s62 offen
  s_mov_b32 s62, 1152
  buffer_load_dword v18, v9, s[28:31], s62 offen
  s_mov_b32 exec_hi, -1
  s_waitcnt vmcnt(0)
  s_endpgm
.globl k2_kernel
.p2align 8
.type k2_kernel,@function
k2_kernel:
  s_cmp_ge_u32 s2, 512
  s_cbranch_scc1 L_k2_end
  s_load_dwordx16 s[4:19], s[0:1], 0
  s_load_dwordx8 s[20:27], s[0:1], 64
  v_and_b32 v1, 63, v0
  v_lshrrev_b32 v16, 6, v0
  s_nop 0
  v_readfirstlane_b32 s40, v16
  s_waitcnt lgkmcnt(0)
  s_cmp_ge_u32 s2, 256
  s_cbranch_scc1 L_k2_sp
  s_setprio 2
  s_and_b32 s60, s2, 7
  s_lshr_b32 s61, s2, 3
  s_and_b32 s62, s60, 3
  s_lshl_b32 s53, s62, 3
  s_lshr_b32 s62, s60, 2
  s_lshl_b32 s62, s62, 2
  s_add_u32 s53, s53, s62
  s_lshr_b32 s62, s61, 3
  s_add_u32 s53, s53, s62
  s_and_b32 s54, s61, 7
  s_and_b32 s55, s40, 3
  s_lshr_b32 s56, s40, 2
  s_mov_b32 s28, s26
  s_mov_b32 s29, s27
  s_mov_b32 s30, 0x800000
  s_mov_b32 s31, 0x20000
  v_lshlrev_b32 v17, 4, v1
  s_lshl_b32 s62, s53, 18
  s_lshl_b32 s63, s55, 10
  s_add_u32 s62, s62, s63
  s_sub_u32 s62, s62, 4096
  s_lshl_b32 s64, s56, 15
  s_add_u32 s59, s62, 98304
  s_add_u32 s65, s59, s64
  s_add_u32 s59, s62, 196608
  s_add_u32 s66, s59, s64
  s_mul_i32 s64, s56, 4160
  s_add_u32 s47, s64, s63
  s_add_u32 s48, s47, 8320
  s_add_u32 s67, s62, 163840
  s_add_u32 s49, s63, 16640
  s_cmp_eq_u32 s56, 1
  s_cselect_b32 s67, s66, s67
  s_cselect_b32 s49, s48, s49
  s_mov_b32 s57, 0
  v_and_b32 v18, 31, v1
  v_lshrrev_b32 v19, 5, v1
L_at_restart:
  s_mov_b32 s44, s65
  s_mov_b32 s45, s66
  s_mov_b32 s46, s67
  s_mov_b32 s58, 0
  s_and_b32 s58, s53, 7
  s_lshl_b32 s62, s58, 12
  s_add_u32 s44, s44, s62
  s_add_u32 s45, s45, s62
  s_add_u32 s46, s46, s62
  s_mov_b32 s50, 0
  s_cmp_eq_u32 s58, 8
  s_cselect_b32 s59, 32768, 0
  s_cselect_b32 s58, 0, s58
  s_sub_u32 s44, s44, s59
  s_sub_u32 s45, s45, s59
  s_sub_u32 s46, s46, s59
  s_add_u32 s58, s58, 1
  s_add_u32 m0, s50, s47
  s_add_u32 s44, s44, 4096
  buffer_load_dwordx4 v17, s[28:31], s44 offen lds
  s_add_u32 m0, s50, s48
  s_add_u32 s45, s45, 4096
  buffer_load_dwordx4 v17, s[28:31], s45 offen lds
  s_add_u32 m0, s50, s49
  s_add_u32 s46, s46, 4096
  buffer_load_dwordx4 v17, s[28:31], s46 offen lds
  s_add_u32 s50, s50, 24960
  s_cmp_eq_u32 s50, 74880
  s_cselect_b32 s50, 0, s50
  s_cmp_lg_u32 s57, 0
  s_cbranch_scc1 L_k2_1
  s_lshl_b32 s62, s54, 8
  s_lshl_b32 s63, s55, 6
  s_add_u32 s62, s62, s63
  v_add_u32 v112, s62, v18
  v_lshlrev_b32 v114, 2, v112
  v_lshlrev_b32 v112, 4, v112
  s_lshl_b32 s63, s53, 18
  v_lshl_add_u32 v113, v19, 15, v112
  buffer_load_dwordx4 v[2:5], v113, s[28:31], s63 offen
  buffer_load_dwordx4 v[8:11], v113, s[28:31], s63 offen offset:512
  s_add_u32 s63, s63, 65536
  buffer_load_dwordx2 v[6:7], v112, s[28:31], s63 offen
  buffer_load_dwordx2 v[12:13], v112, s[28:31], s63 offen offset:512
  s_add_u32 s32, s26, 0xec0000
  s_addc_u32 s33, s27, 0
  s_mov_b32 s34, 0x2000
  s_mov_b32 s35, 0x20000
  s_lshl_b32 s63, s56, 7
  buffer_load_dword v127, v114, s[32:35], s63 offen
  v_mov_b32 v116, 0x00003f80
  v_mov_b32 v117, 0x00000000
  v_mov_b32 v118, 0x00000000
  v_mov_b32 v119, 0x00000000
  v_and_b32 v114, 255, v0
  v_lshlrev_b32 v114, 4, v114
  ds_write_b128 v114, v[116:119] offset:20800
  ds_write_b128 v114, v[116:119] offset:45760
  v_add_u32 v114, 49920, v114
  ds_write_b128 v114, v[116:119] offset:20800
L_k2_1:
  s_cmp_eq_u32 s58, 8
  s_cselect_b32 s59, 32768, 0
  s_cselect_b32 s58, 0, s58
  s_sub_u32 s44, s44, s59
  s_sub_u32 s45, s45, s59
  s_sub_u32 s46, s46, s59
  s_add_u32 s58, s58, 1
  s_add_u32 m0, s50, s47
  s_add_u32 s44, s44, 4096
  buffer_load_dwordx4 v17, s[28:31], s44 offen lds
  s_add_u32 m0, s50, s48
  s_add_u32 s45, s45, 4096
  buffer_load_dwordx4 v17, s[28:31], s45 offen lds
  s_add_u32 m0, s50, s49
  s_add_u32 s46, s46, 4096
  buffer_load_dwordx4 v17, s[28:31], s46 offen lds
  s_add_u32 s50, s50, 24960
  s_cmp_eq_u32 s50, 74880
  s_cselect_b32 s50, 0, s50
  s_lshl_b32 s62, s56, 11
  v_lshlrev_b32 v112, 4, v18
  v_add_u32 v112, s62, v112
  s_movk_i32 s63, 4160
  v_mad_u32_u24 v14, v19, s63, v112
  v_add_u32 v15, 16640, v112
  v_mov_b32 v113, 20808
  v_cmp_eq_u32 vcc, 1, v19
  s_nop 1
  v_cndmask_b32 v15, v15, v113, vcc
  v_bfe_u32 v113, v1, 4, 1
  v_bfe_u32 v114, v1, 2, 2
  v_and_b32 v115, 3, v1
  v_lshl_add_u32 v114, v19, 2, v114
  v_lshlrev_b32 v114, 4, v114
  v_add_u32 v114, s62, v114
  v_lshrrev_b32 v116, 1, v115
  v_add_u32 v116, 2, v116
  v_mul_u32_u24 v116, 4160, v116
  v_and_b32 v117, 1, v115
  v_lshl_add_u32 v116, v117, 3, v116
  v_mov_b32 v117, 20808
  v_mov_b32 v118, 16648
  v_mov_b32 v119, 20800
  v_cmp_eq_u32 vcc, 0, v115
  v_cmp_eq_u32_e64 s[62:63], 1, v115
  s_nop 1
  v_cndmask_b32 v117, v117, v118, vcc
  v_cndmask_b32_e64 v117, v117, v119, s[62:63]
  v_cmp_eq_u32 vcc, 1, v113
  s_nop 1
  v_cndmask_b32 v116, v116, v117, vcc
  v_add_u32 v16, v116, v114
  v_mov_b32 v80, 0
  v_mov_b32 v96, 0
  v_mov_b32 v81, 0
  v_mov_b32 v97, 0
  v_mov_b32 v82, 0
  v_mov_b32 v98, 0
  v_mov_b32 v83, 0
  v_mov_b32 v99, 0
  v_mov_b32 v84, 0
  v_mov_b32 v100, 0
  v_mov_b32 v85, 0
  v_mov_b32 v101, 0
  v_mov_b32 v86, 0
  v_mov_b32 v102, 0
  v_mov_b32 v87, 0
  v_mov_b32 v103, 0
  v_mov_b32 v88, 0
  v_mov_b32 v104, 0
  v_mov_b32 v89, 0
  v_mov_b32 v105, 0
  v_mov_b32 v90, 0
  v_mov_b32 v106, 0
  v_mov_b32 v91, 0
  v_mov_b32 v107, 0
  v_mov_b32 v92, 0
  v_mov_b32 v108, 0
  v_mov_b32 v93, 0
  v_mov_b32 v109, 0
  v_mov_b32 v94, 0
  v_mov_b32 v110, 0
  v_mov_b32 v95, 0
  v_mov_b32 v111, 0
  v_mov_b32 v72, 0
  v_mov_b32 v73, 0
  v_mov_b32 v74, 0
  v_mov_b32 v75, 0
  v_mov_b32 v44, 0
  v_mov_b32 v45, 0
  v_mov_b32 v46, 0
  v_mov_b32 v47, 0
  s_waitcnt vmcnt(3) lgkmcnt(0)
  s_cmp_lg_u32 s57, 0
  s_cbranch_scc1 L_k2_2
  v_cmp_eq_u32 vcc, 1, v19
  s_nop 1
  v_cndmask_b32_e64 v6, v6, 0, vcc
  v_cndmask_b32_e64 v7, v7, 0, vcc
  v_cndmask_b32_e64 v12, v12, 0, vcc
  v_cndmask_b32_e64 v13, v13, 0, vcc
L_k2_2:
  s_barrier
  ds_read_b128 v[20:23], v14 offset:0
  ds_read_b64 v[24:25], v15 offset:0
  ds_read_b128 v[26:29], v14 offset:512
  ds_read_b64 v[30:31], v15 offset:512
  ds_read_b64_tr_b16 v[32:33], v16 offset:0
  ds_read_b64_tr_b16 v[34:35], v16 offset:128
  ds_read_b64_tr_b16 v[36:37], v16 offset:256
  ds_read_b64_tr_b16 v[38:39], v16 offset:384
  s_mov_b32 s52, 0
  s_mov_b32 s51, 24960
  s_waitcnt lgkmcnt(0)
  v_mfma_f32_32x32x16_bf16 v[48:63], v[20:23], v[2:5], 0
  v_mfma_f32_32x32x8_bf16 v[48:63], v[24:25], v[6:7], v[48:63]
  s_nop 11
  s_cmp_eq_u32 s56, 1
  s_cbranch_scc1 L_at_loop1
L_at_loop:
  s_waitcnt lgkmcnt(0)
  s_setprio 2
  v_exp_f32 v48, v48
  v_exp_f32 v49, v49
  v_mfma_f32_32x32x16_bf16 v[96:111], v[44:47], v[72:75], v[96:111]
  ds_read_b64_tr_b16 v[40:41], v16 offset:512
  ds_read_b64_tr_b16 v[42:43], v16 offset:640
  ds_read_b64_tr_b16 v[44:45], v16 offset:768
  ds_read_b64_tr_b16 v[46:47], v16 offset:896
  v_exp_f32 v50, v50
  v_exp_f32 v51, v51
  v_exp_f32 v52, v52
  v_exp_f32 v53, v53
  v_mfma_f32_32x32x16_bf16 v[64:79], v[20:23], v[8:11], 0
  v_exp_f32 v54, v54
  v_exp_f32 v55, v55
  v_cvt_pk_bf16_f32 v48, v48, v49
  v_cvt_pk_bf16_f32 v49, v50, v51
  v_mfma_f32_32x32x8_bf16 v[64:79], v[24:25], v[12:13], v[64:79]
  ds_read_b128 v[20:23], v14 offset:1024
  ds_read_b64 v[24:25], v15 offset:1024
  v_cvt_pk_bf16_f32 v50, v52, v53
  v_cvt_pk_bf16_f32 v51, v54, v55
  v_exp_f32 v56, v56
  v_exp_f32 v57, v57
  v_mfma_f32_32x32x16_bf16 v[80:95], v[32:35], v[48:51], v[80:95]
  v_exp_f32 v58, v58
  v_exp_f32 v59, v59
  v_exp_f32 v60, v60
  v_exp_f32 v61, v61
  v_exp_f32 v62, v62
  v_exp_f32 v63, v63
  v_cvt_pk_bf16_f32 v56, v56, v57
  v_cvt_pk_bf16_f32 v57, v58, v59
  v_cvt_pk_bf16_f32 v58, v60, v61
  v_cvt_pk_bf16_f32 v59, v62, v63
  v_exp_f32 v64, v64
  v_exp_f32 v65, v65
  v_mfma_f32_32x32x16_bf16 v[80:95], v[36:39], v[56:59], v[80:95]
  v_exp_f32 v66, v66
  v_exp_f32 v67, v67
  v_exp_f32 v68, v68
  v_exp_f32 v69, v69
  v_mfma_f32_32x32x16_bf16 v[48:63], v[26:29], v[2:5], 0
  v_exp_f32 v70, v70
  v_exp_f32 v71, v71
  v_cvt_pk_bf16_f32 v64, v64, v65
  v_cvt_pk_bf16_f32 v65, v66, v67
  v_mfma_f32_32x32x8_bf16 v[48:63], v[30:31], v[6:7], v[48:63]
  v_cvt_pk_bf16_f32 v66, v68, v69
  v_cvt_pk_bf16_f32 v67, v70, v71
  v_exp_f32 v72, v72
  v_exp_f32 v73, v73
  v_mfma_f32_32x32x16_bf16 v[96:111], v[32:35], v[64:67], v[96:111]
  v_exp_f32 v74, v74
  v_exp_f32 v75, v75
  v_exp_f32 v76, v76
  v_exp_f32 v77, v77
  v_exp_f32 v78, v78
  v_exp_f32 v79, v79
  v_cvt_pk_bf16_f32 v72, v72, v73
  v_cvt_pk_bf16_f32 v73, v74, v75
  v_cvt_pk_bf16_f32 v74, v76, v77
  v_cvt_pk_bf16_f32 v75, v78, v79
  s_waitcnt lgkmcnt(0)
  s_setprio 1
  v_exp_f32 v48, v48
  v_exp_f32 v49, v49
  v_mfma_f32_32x32x16_bf16 v[96:111], v[36:39], v[72:75], v[96:111]
  ds_read_b64_tr_b16 v[32:33], v16 offset:1024
  ds_read_b64_tr_b16 v[34:35], v16 offset:1152
  ds_read_b64_tr_b16 v[36:37], v16 offset:1280
  ds_read_b64_tr_b16 v[38:39], v16 offset:1408
  v_exp_f32 v50, v50
  v_exp_f32 v51, v51
  v_exp_f32 v52, v52
  v_exp_f32 v53, v53
  v_mfma_f32_32x32x16_bf16 v[64:79], v[26:29], v[8:11], 0
  v_exp_f32 v54, v54
  v_exp_f32 v55, v55
  v_cvt_pk_bf16_f32 v48, v48, v49
  v_cvt_pk_bf16_f32 v49, v50, v51
  v_mfma_f32_32x32x8_bf16 v[64:79], v[30:31], v[12:13], v[64:79]
  ds_read_b128 v[26:29], v14 offset:1536
  ds_read_b64 v[30:31], v15 offset:1536
  v_cvt_pk_bf16_f32 v50, v52, v53
  v_cvt_pk_bf16_f32 v51, v54, v55
  v_exp_f32 v56, v56
  v_exp_f32 v57, v57
  v_mfma_f32_32x32x16_bf16 v[80:95], v[40:43], v[48:51], v[80:95]
  v_exp_f32 v58, v58
  v_exp_f32 v59, v59
  v_exp_f32 v60, v60
  v_exp_f32 v61, v61
  v_exp_f32 v62, v62
  v_exp_f32 v63, v63
  v_cvt_pk_bf16_f32 v56, v56, v57
  v_cvt_pk_bf16_f32 v57, v58, v59
  v_cvt_pk_bf16_f32 v58, v60, v61
  v_cvt_pk_bf16_f32 v59, v62, v63
  v_exp_f32 v64, v64
  v_exp_f32 v65, v65
  v_mfma_f32_32x32x16_bf16 v[80:95], v[44:47], v[56:59], v[80:95]
  v_exp_f32 v66, v66
  v_exp_f32 v67, v67
  v_exp_f32 v68, v68
  v_exp_f32 v69, v69
  v_mfma_f32_32x32x16_bf16 v[48:63], v[20:23], v[2:5], 0
  v_exp_f32 v70, v70
  v_exp_f32 v71, v71
  v_cvt_pk_bf16_f32 v64, v64, v65
  v_cvt_pk_bf16_f32 v65, v66, v67
  v_mfma_f32_32x32x8_bf16 v[48:63], v[24:25], v[6:7], v[48:63]
  v_cvt_pk_bf16_f32 v66, v68, v69
  v_cvt_pk_bf16_f32 v67, v70, v71
  v_exp_f32 v72, v72
  v_exp_f32 v73, v73
  v_mfma_f32_32x32x16_bf16 v[96:111], v[40:43], v[64:67], v[96:111]
  v_exp_f32 v74, v74
  v_exp_f32 v75, v75
  v_exp_f32 v76, v76
  v_exp_f32 v77, v77
  v_exp_f32 v78, v78
  v_exp_f32 v79, v79
  v_cvt_pk_bf16_f32 v72, v72, v73
  v_cvt_pk_bf16_f32 v73, v74, v75
  v_cvt_pk_bf16_f32 v74, v76, v77
  v_cvt_pk_bf16_f32 v75, v78, v79
  s_waitcnt vmcnt(0) lgkmcnt(0)
  s_barrier
  v_add_u32 v14, s51, v14
  v_add_u32 v15, s51, v15
  s_setprio 2
  v_exp_f32 v48, v48
  v_exp_f32 v49, v49
  v_mfma_f32_32x32x16_bf16 v[96:111], v[44:47], v[72:75], v[96:111]
  ds_read_b64_tr_b16 v[40:41], v16 offset:1536
  ds_read_b64_tr_b16 v[42:43], v16 offset:1664
  ds_read_b64_tr_b16 v[44:45], v16 offset:1792
  ds_read_b64_tr_b16 v[46:47], v16 offset:1920
  v_exp_f32 v50, v50
  v_exp_f32 v51, v51
  v_exp_f32 v52, v52
  v_exp_f32 v53, v53
  v_mfma_f32_32x32x16_bf16 v[64:79], v[20:23], v[8:11], 0
  v_exp_f32 v54, v54
  v_exp_f32 v55, v55
  v_cvt_pk_bf16_f32 v48, v48, v49
  v_cvt_pk_bf16_f32 v49, v50, v51
  v_mfma_f32_32x32x8_bf16 v[64:79], v[24:25], v[12:13], v[64:79]
  ds_read_b128 v[20:23], v14 offset:0
  ds_read_b64 v[24:25], v15 offset:0
  v_cvt_pk_bf16_f32 v50, v52, v53
  v_cvt_pk_bf16_f32 v51, v54, v55
  v_exp_f32 v56, v56
  v_exp_f32 v57, v57
  v_mfma_f32_32x32x16_bf16 v[80:95], v[32:35], v[48:51], v[80:95]
  s_cmp_ge_u32 s52, 6
  s_cbranch_scc1 L_k2_3
  s_cmp_eq_u32 s58, 8
  s_cselect_b32 s59, 32768, 0
  s_cselect_b32 s58, 0, s58
  s_sub_u32 s44, s44, s59
  s_sub_u32 s45, s45, s59
  s_sub_u32 s46, s46, s59
  s_add_u32 s58, s58, 1
  s_add_u32 m0, s50, s47
  s_add_u32 s44, s44, 4096
  buffer_load_dwordx4 v17, s[28:31], s44 offen lds
L_k2_3:
  v_exp_f32 v58, v58
  v_exp_f32 v59, v59
  v_exp_f32 v60, v60
  v_exp_f32 v61, v61
  v_exp_f32 v62, v62
  v_exp_f32 v63, v63
  v_cvt_pk_bf16_f32 v56, v56, v57
  v_cvt_pk_bf16_f32 v57, v58, v59
  v_cvt_pk_bf16_f32 v58, v60, v61
  v_cvt_pk_bf16_f32 v59, v62, v63
  v_exp_f32 v64, v64
  v_exp_f32 v65, v65
  v_mfma_f32_32x32x16_bf16 v[80:95], v[36:39], v[56:59], v[80:95]
  s_cmp_ge_u32 s52, 6
  s_cbranch_scc1 L_k2_4
  s_add_u32 m0, s50, s48
  s_add_u32 s45, s45, 4096
  buffer_load_dwordx4 v17, s[28:31], s45 offen lds
L_k2_4:
  v_exp_f32 v66, v66
  v_exp_f32 v67, v67
  v_exp_f32 v68, v68
  v_exp_f32 v69, v69
  v_mfma_f32_32x32x16_bf16 v[48:63], v[26:29], v[2:5], 0
  v_exp_f32 v70, v70
  v_exp_f32 v71, v71
  v_cvt_pk_bf16_f32 v64, v64, v65
  v_cvt_pk_bf16_f32 v65, v66, v67
  v_mfma_f32_32x32x8_bf16 v[48:63], v[30:31], v[6:7], v[48:63]
  v_cvt_pk_bf16_f32 v66, v68, v69
  v_cvt_pk_bf16_f32 v67, v70, v71
  v_exp_f32 v72, v72
  v_exp_f32 v73, v73
  v_mfma_f32_32x32x16_bf16 v[96:111], v[32:35], v[64:67], v[96:111]
  s_cmp_ge_u32 s52, 6
  s_cbranch_scc1 L_k2_5
  s_add_u32 m0, s50, s49
  s_add_u32 s46, s46, 4096
  buffer_load_dwordx4 v17, s[28:31], s46 offen lds
  s_add_u32 s50, s50, 24960
  s_cmp_eq_u32 s50, 74880
  s_cselect_b32 s50, 0, s50
L_k2_5:
  v_exp_f32 v74, v74
  v_exp_f32 v75, v75
  v_exp_f32 v76, v76
  v_exp_f32 v77, v77
  v_exp_f32 v78, v78
  v_exp_f32 v79, v79
  v_cvt_pk_bf16_f32 v72, v72, v73
  v_cvt_pk_bf16_f32 v73, v74, v75
  v_cvt_pk_bf16_f32 v74, v76, v77
  v_cvt_pk_bf16_f32 v75, v78, v79
  s_waitcnt lgkmcnt(0)
  v_add_u32 v16, s51, v16
  s_setprio 1
  v_exp_f32 v48, v48
  v_exp_f32 v49, v49
  v_mfma_f32_32x32x16_bf16 v[96:111], v[36:39], v[72:75], v[96:111]
  ds_read_b64_tr_b16 v[32:33], v16 offset:0
  ds_read_b64_tr_b16 v[34:35], v16 offset:128
  ds_read_b64_tr_b16 v[36:37], v16 offset:256
  ds_read_b64_tr_b16 v[38:39], v16 offset:384
  v_exp_f32 v50, v50
  v_exp_f32 v51, v51
  v_exp_f32 v52, v52
  v_exp_f32 v53, v53
  v_mfma_f32_32x32x16_bf16 v[64:79], v[26:29], v[8:11], 0
  v_exp_f32 v54, v54
  v_exp_f32 v55, v55
  v_cvt_pk_bf16_f32 v48, v48, v49
  v_cvt_pk_bf16_f32 v49, v50, v51
  v_mfma_f32_32x32x8_bf16 v[64:79], v[30:31], v[12:13], v[64:79]
  ds_read_b128 v[26:29], v14 offset:512
  ds_read_b64 v[30:31], v15 offset:512
  v_cvt_pk_bf16_f32 v50, v52, v53
  v_cvt_pk_bf16_f32 v51, v54, v55
  v_exp_f32 v56, v56
  v_exp_f32 v57, v57
  v_mfma_f32_32x32x16_bf16 v[80:95], v[40:43], v[48:51], v[80:95]
  v_exp_f32 v58, v58
  v_exp_f32 v59, v59
  v_exp_f32 v60, v60
  v_exp_f32 v61, v61
  v_exp_f32 v62, v62
  v_exp_f32 v63, v63
  v_cvt_pk_bf16_f32 v56, v56, v57
  v_cvt_pk_bf16_f32 v57, v58, v59
  v_cvt_pk_bf16_f32 v58, v60, v61
  v_cvt_pk_bf16_f32 v59, v62, v63
  v_exp_f32 v64, v64
  v_exp_f32 v65, v65
  v_mfma_f32_32x32x16_bf16 v[80:95], v[44:47], v[56:59], v[80:95]
  v_exp_f32 v66, v66
  v_exp_f32 v67, v67
  v_exp_f32 v68, v68
  v_exp_f32 v69, v69
  v_mfma_f32_32x32x16_bf16 v[48:63], v[20:23], v[2:5], 0
  v_exp_f32 v70, v70
  v_exp_f32 v71, v71
  v_cvt_pk_bf16_f32 v64, v64, v65
  v_cvt_pk_bf16_f32 v65, v66, v67
  v_mfma_f32_32x32x8_bf16 v[48:63], v[24:25], v[6:7], v[48:63]
  v_cvt_pk_bf16_f32 v66, v68, v69
  v_cvt_pk_bf16_f32 v67, v70, v71
  v_exp_f32 v72, v72
  v_exp_f32 v73, v73
  v_mfma_f32_32x32x16_bf16 v[96:111], v[40:43], v[64:67], v[96:111]
  v_exp_f32 v74, v74
  v_exp_f32 v75, v75
  v_exp_f32 v76, v76
  v_exp_f32 v77, v77
  v_exp_f32 v78, v78
  v_exp_f32 v79, v79
  v_cvt_pk_bf16_f32 v72, v72, v73
  v_cvt_pk_bf16_f32 v73, v74, v75
  v_cvt_pk_bf16_f32 v74, v76, v77
  v_cvt_pk_bf16_f32 v75, v78, v79
  s_add_u32 s52, s52, 1
  s_mov_b32 s51, 24960
  s_cmp_eq_u32 s52, 2
  s_cselect_b32 s51, -49920, s51
  s_cmp_eq_u32 s52, 5
  s_cselect_b32 s51, -49920, s51
  s_cmp_lt_u32 s52, 8
  s_cbranch_scc1 L_at_loop
  s_branch L_at_after
L_at_loop1:
  s_waitcnt lgkmcnt(0)
  s_setprio 1
  v_exp_f32 v48, v48
  v_exp_f32 v49, v49
  v_mfma_f32_32x32x16_bf16 v[96:111], v[44:47], v[72:75], v[96:111]
  ds_read_b64_tr_b16 v[40:41], v16 offset:512
  ds_read_b64_tr_b16 v[42:43], v16 offset:640
  ds_read_b64_tr_b16 v[44:45], v16 offset:768
  ds_read_b64_tr_b16 v[46:47], v16 offset:896
  v_exp_f32 v50, v50
  v_exp_f32 v51, v51
  v_exp_f32 v52, v52
  v_exp_f32 v53, v53
  v_mfma_f32_32x32x16_bf16 v[64:79], v[20:23], v[8:11], 0
  v_exp_f32 v54, v54
  v_exp_f32 v55, v55
  v_cvt_pk_bf16_f32 v48, v48, v49
  v_cvt_pk_bf16_f32 v49, v50, v51
  v_mfma_f32_32x32x8_bf16 v[64:79], v[24:25], v[12:13], v[64:79]
  ds_read_b128 v[20:23], v14 offset:1024
  ds_read_b64 v[24:25], v15 offset:1024
  v_cvt_pk_bf16_f32 v50, v52, v53
  v_cvt_pk_bf16_f32 v51, v54, v55
  v_exp_f32 v56, v56
  v_exp_f32 v57, v57
  v_mfma_f32_32x32x16_bf16 v[80:95], v[32:35], v[48:51], v[80:95]
  v_exp_f32 v58, v58
  v_exp_f32 v59, v59
  v_exp_f32 v60, v60
  v_exp_f32 v61, v61
  v_exp_f32 v62, v62
  v_exp_f32 v63, v63
  v_cvt_pk_bf16_f32 v56, v56, v57
  v_cvt_pk_bf16_f32 v57, v58, v59
  v_cvt_pk_bf16_f32 v58, v60, v61
  v_cvt_pk_bf16_f32 v59, v62, v63
  v_exp_f32 v64, v64
  v_exp_f32 v65, v65
  v_mfma_f32_32x32x16_bf16 v[80:95], v[36:39], v[56:59], v[80:95]
  v_exp_f32 v66, v66
  v_exp_f32 v67, v67
  v_exp_f32 v68, v68
  v_exp_f32 v69, v69
  v_mfma_f32_32x32x16_bf16 v[48:63], v[26:29], v[2:5], 0
  v_exp_f32 v70, v70
  v_exp_f32 v71, v71
  v_cvt_pk_bf16_f32 v64, v64, v65
  v_cvt_pk_bf16_f32 v65, v66, v67
  v_mfma_f32_32x32x8_bf16 v[48:63], v[30:31], v[6:7], v[48:63]
  v_cvt_pk_bf16_f32 v66, v68, v69
  v_cvt_pk_bf16_f32 v67, v70, v71
  v_exp_f32 v72, v72
  v_exp_f32 v73, v73
  v_mfma_f32_32x32x16_bf16 v[96:111], v[32:35], v[64:67], v[96:111]
  v_exp_f32 v74, v74
  v_exp_f32 v75, v75
  v_exp_f32 v76, v76
  v_exp_f32 v77, v77
  v_exp_f32 v78, v78
  v_exp_f32 v79, v79
  v_cvt_pk_bf16_f32 v72, v72, v73
  v_cvt_pk_bf16_f32 v73, v74, v75
  v_cvt_pk_bf16_f32 v74, v76, v77
  v_cvt_pk_bf16_f32 v75, v78, v79
  s_waitcnt lgkmcnt(0)
  s_setprio 2
  v_exp_f32 v48, v48
  v_exp_f32 v49, v49
  v_mfma_f32_32x32x16_bf16 v[96:111], v[36:39], v[72:75], v[96:111]
  ds_read_b64_tr_b16 v[32:33], v16 offset:1024
  ds_read_b64_tr_b16 v[34:35], v16 offset:1152
  ds_read_b64_tr_b16 v[36:37], v16 offset:1280
  ds_read_b64_tr_b16 v[38:39], v16 offset:1408
  v_exp_f32 v50, v50
  v_exp_f32 v51, v51
  v_exp_f32 v52, v52
  v_exp_f32 v53, v53
  v_mfma_f32_32x32x16_bf16 v[64:79], v[26:29], v[8:11], 0
  v_exp_f32 v54, v54
  v_exp_f32 v55, v55
  v_cvt_pk_bf16_f32 v48, v48, v49
  v_cvt_pk_bf16_f32 v49, v50, v51
  v_mfma_f32_32x32x8_bf16 v[64:79], v[30:31], v[12:13], v[64:79]
  ds_read_b128 v[26:29], v14 offset:1536
  ds_read_b64 v[30:31], v15 offset:1536
  v_cvt_pk_bf16_f32 v50, v52, v53
  v_cvt_pk_bf16_f32 v51, v54, v55
  v_exp_f32 v56, v56
  v_exp_f32 v57, v57
  v_mfma_f32_32x32x16_bf16 v[80:95], v[40:43], v[48:51], v[80:95]
  v_exp_f32 v58, v58
  v_exp_f32 v59, v59
  v_exp_f32 v60, v60
  v_exp_f32 v61, v61
  v_exp_f32 v62, v62
  v_exp_f32 v63, v63
  v_cvt_pk_bf16_f32 v56, v56, v57
  v_cvt_pk_bf16_f32 v57, v58, v59
  v_cvt_pk_bf16_f32 v58, v60, v61
  v_cvt_pk_bf16_f32 v59, v62, v63
  v_exp_f32 v64, v64
  v_exp_f32 v65, v65
  v_mfma_f32_32x32x16_bf16 v[80:95], v[44:47], v[56:59], v[80:95]
  v_exp_f32 v66, v66
  v_exp_f32 v67, v67
  v_exp_f32 v68, v68
  v_exp_f32 v69, v69
  v_mfma_f32_32x32x16_bf16 v[48:63], v[20:23], v[2:5], 0
  v_exp_f32 v70, v70
  v_exp_f32 v71, v71
  v_cvt_pk_bf16_f32 v64, v64, v65
  v_cvt_pk_bf16_f32 v65, v66, v67
  v_mfma_f32_32x32x8_bf16 v[48:63], v[24:25], v[6:7], v[48:63]
  v_cvt_pk_bf16_f32 v66, v68, v69
  v_cvt_pk_bf16_f32 v67, v70, v71
  v_exp_f32 v72, v72
  v_exp_f32 v73, v73
  v_mfma_f32_32x32x16_bf16 v[96:111], v[40:43], v[64:67], v[96:111]
  v_exp_f32 v74, v74
  v_exp_f32 v75, v75
  v_exp_f32 v76, v76
  v_exp_f32 v77, v77
  v_exp_f32 v78, v78
  v_exp_f32 v79, v79
  v_cvt_pk_bf16_f32 v72, v72, v73
  v_cvt_pk_bf16_f32 v73, v74, v75
  v_cvt_pk_bf16_f32 v74, v76, v77
  v_cvt_pk_bf16_f32 v75, v78, v79
  s_waitcnt vmcnt(0) lgkmcnt(0)
  s_barrier
  v_add_u32 v14, s51, v14
  v_add_u32 v15, s51, v15
  s_setprio 1
  v_exp_f32 v48, v48
  v_exp_f32 v49, v49
  v_mfma_f32_32x32x16_bf16 v[96:111], v[44:47], v[72:75], v[96:111]
  ds_read_b64_tr_b16 v[40:41], v16 offset:1536
  ds_read_b64_tr_b16 v[42:43], v16 offset:1664
  ds_read_b64_tr_b16 v[44:45], v16 offset:1792
  ds_read_b64_tr_b16 v[46:47], v16 offset:1920
  v_exp_f32 v50, v50
  v_exp_f32 v51, v51
  v_exp_f32 v52, v52
  v_exp_f32 v53, v53
  v_mfma_f32_32x32x16_bf16 v[64:79], v[20:23], v[8:11], 0
  v_exp_f32 v54, v54
  v_exp_f32 v55, v55
  v_cvt_pk_bf16_f32 v48, v48, v49
  v_cvt_pk_bf16_f32 v49, v50, v51
  v_mfma_f32_32x32x8_bf16 v[64:79], v[24:25], v[12:13], v[64:79]
  ds_read_b128 v[20:23], v14 offset:0
  ds_read_b64 v[24:25], v15 offset:0
  v_cvt_pk_bf16_f32 v50, v52, v53
  v_cvt_pk_bf16_f32 v51, v54, v55
  v_exp_f32 v56, v56
  v_exp_f32 v57, v57
  v_mfma_f32_32x32x16_bf16 v[80:95], v[32:35], v[48:51], v[80:95]
  v_exp_f32 v58, v58
  v_exp_f32 v59, v59
  v_exp_f32 v60, v60
  v_exp_f32 v61, v61
  v_exp_f32 v62, v62
  v_exp_f32 v63, v63
  v_cvt_pk_bf16_f32 v56, v56, v57
  v_cvt_pk_bf16_f32 v57, v58, v59
  v_cvt_pk_bf16_f32 v58, v60, v61
  v_cvt_pk_bf16_f32 v59, v62, v63
  v_exp_f32 v64, v64
  v_exp_f32 v65, v65
  v_mfma_f32_32x32x16_bf16 v[80:95], v[36:39], v[56:59], v[80:95]
  v_exp_f32 v66, v66
  v_exp_f32 v67, v67
  v_exp_f32 v68, v68
  v_exp_f32 v69, v69
  v_mfma_f32_32x32x16_bf16 v[48:63], v[26:29], v[2:5], 0
  v_exp_f32 v70, v70
  v_exp_f32 v71, v71
  v_cvt_pk_bf16_f32 v64, v64, v65
  v_cvt_pk_bf16_f32 v65, v66, v67
  v_mfma_f32_32x32x8_bf16 v[48:63], v[30:31], v[6:7], v[48:63]
  v_cvt_pk_bf16_f32 v66, v68, v69
  v_cvt_pk_bf16_f32 v67, v70, v71
  v_exp_f32 v72, v72
  v_exp_f32 v73, v73
  v_mfma_f32_32x32x16_bf16 v[96:111], v[32:35], v[64:67], v[96:111]
  v_exp_f32 v74, v74
  v_exp_f32 v75, v75
  v_exp_f32 v76, v76
  v_exp_f32 v77, v77
  v_exp_f32 v78, v78
  v_exp_f32 v79, v79
  v_cvt_pk_bf16_f32 v72, v72, v73
  v_cvt_pk_bf16_f32 v73, v74, v75
  v_cvt_pk_bf16_f32 v74, v76, v77
  v_cvt_pk_bf16_f32 v75, v78, v79
  s_waitcnt lgkmcnt(0)
  v_add_u32 v16, s51, v16
  s_setprio 2
  v_exp_f32 v48, v48
  v_exp_f32 v49, v49
  v_mfma_f32_32x32x16_bf16 v[96:111], v[36:39], v[72:75], v[96:111]
  ds_read_b64_tr_b16 v[32:33], v16 offset:0
  ds_read_b64_tr_b16 v[34:35], v16 offset:128
  ds_read_b64_tr_b16 v[36:37], v16 offset:256
  ds_read_b64_tr_b16 v[38:39], v16 offset:384
  v_exp_f32 v50, v50
  v_exp_f32 v51, v51
  v_exp_f32 v52, v52
  v_exp_f32 v53, v53
  v_mfma_f32_32x32x16_bf16 v[64:79], v[26:29], v[8:11], 0
  v_exp_f32 v54, v54
  v_exp_f32 v55, v55
  v_cvt_pk_bf16_f32 v48, v48, v49
  v_cvt_pk_bf16_f32 v49, v50, v51
  v_mfma_f32_32x32x8_bf16 v[64:79], v[30:31], v[12:13], v[64:79]
  ds_read_b128 v[26:29], v14 offset:512
  ds_read_b64 v[30:31], v15 offset:512
  v_cvt_pk_bf16_f32 v50, v52, v53
  v_cvt_pk_bf16_f32 v51, v54, v55
  v_exp_f32 v56, v56
  v_exp_f32 v57, v57
  v_mfma_f32_32x32x16_bf16 v[80:95], v[40:43], v[48:51], v[80:95]
  s_cmp_ge_u32 s52, 6
  s_cbranch_scc1 L_k2_6
  s_cmp_eq_u32 s58, 8
  s_cselect_b32 s59, 32768, 0
  s_cselect_b32 s58, 0, s58
  s_sub_u32 s44, s44, s59
  s_sub_u32 s45, s45, s59
  s_sub_u32 s46, s46, s59
  s_add_u32 s58, s58, 1
  s_add_u32 m0, s50, s47
  s_add_u32 s44, s44, 4096
  buffer_load_dwordx4 v17, s[28:31], s44 offen lds
L_k2_6:
  v_exp_f32 v58, v58
  v_exp_f32 v59, v59
  v_exp_f32 v60, v60
  v_exp_f32 v61, v61
  v_exp_f32 v62, v62
  v_exp_f32 v63, v63
  v_cvt_pk_bf16_f32 v56, v56, v57
  v_cvt_pk_bf16_f32 v57, v58, v59
  v_cvt_pk_bf16_f32 v58, v60, v61
  v_cvt_pk_bf16_f32 v59, v62, v63
  v_exp_f32 v64, v64
  v_exp_f32 v65, v65
  v_mfma_f32_32x32x16_bf16 v[80:95], v[44:47], v[56:59], v[80:95]
  s_cmp_ge_u32 s52, 6
  s_cbranch_scc1 L_k2_7
  s_add_u32 m0, s50, s48
  s_add_u32 s45, s45, 4096
  buffer_load_dwordx4 v17, s[28:31], s45 offen lds
L_k2_7:
  v_exp_f32 v66, v66
  v_exp_f32 v67, v67
  v_exp_f32 v68, v68
  v_exp_f32 v69, v69
  v_mfma_f32_32x32x16_bf16 v[48:63], v[20:23], v[2:5], 0
  v_exp_f32 v70, v70
  v_exp_f32 v71, v71
  v_cvt_pk_bf16_f32 v64, v64, v65
  v_cvt_pk_bf16_f32 v65, v66, v67
  v_mfma_f32_32x32x8_bf16 v[48:63], v[24:25], v[6:7], v[48:63]
  v_cvt_pk_bf16_f32 v66, v68, v69
  v_cvt_pk_bf16_f32 v67, v70, v71
  v_exp_f32 v72, v72
  v_exp_f32 v73, v73
  v_mfma_f32_32x32x16_bf16 v[96:111], v[40:43], v[64:67], v[96:111]
  s_cmp_ge_u32 s52, 6
  s_cbranch_scc1 L_k2_8
  s_add_u32 m0, s50, s49
  s_add_u32 s46, s46, 4096
  buffer_load_dwordx4 v17, s[28:31], s46 offen lds
  s_add_u32 s50, s50, 24960
  s_cmp_eq_u32 s50, 74880
  s_cselect_b32 s50, 0, s50
L_k2_8:
  v_exp_f32 v74, v74
  v_exp_f32 v75, v75
  v_exp_f32 v76, v76
  v_exp_f32 v77, v77
  v_exp_f32 v78, v78
  v_exp_f32 v79, v79
  v_cvt_pk_bf16_f32 v72, v72, v73
  v_cvt_pk_bf16_f32 v73, v74, v75
  v_cvt_pk_bf16_f32 v74, v76, v77
  v_cvt_pk_bf16_f32 v75, v78, v79
  s_add_u32 s52, s52, 1
  s_mov_b32 s51, 24960
  s_cmp_eq_u32 s52, 2
  s_cselect_b32 s51, -49920, s51
  s_cmp_eq_u32 s52, 5
  s_cselect_b32 s51, -49920, s51
  s_cmp_lt_u32 s52, 8
  s_cbranch_scc1 L_at_loop1
L_at_after:
  s_nop 1
  v_mfma_f32_32x32x16_bf16 v[96:111], v[44:47], v[72:75], v[96:111]
  s_setprio 3
  s_xor_b32 s64, s56, 1
  s_lshl_b32 s62, s55, 1
  s_add_u32 s62, s62, s64
  s_lshl_b32 s63, s62, 12
  s_cmp_ge_u32 s62, 6
  s_cselect_b32 s62, 25344, 0
  s_add_u32 s63, s63, s62
  v_add_u32 v112, s63, v17
  s_lshl_b32 s62, s55, 1
  s_add_u32 s62, s62, s56
  s_lshl_b32 s63, s62, 12
  s_cmp_ge_u32 s62, 6
  s_cselect_b32 s62, 25344, 0
  s_add_u32 s63, s63, s62
  v_add_u32 v113, s63, v17
  s_nop 7
  s_mov_b32 s64, 0
  s_cmp_lg_u32 s57, 0
  s_cbranch_scc1 L_k2_9
  v_mul_f32 v119, 0, v80
  v_mul_f32 v120, 0, v96
  v_fma_f32 v119, v81, 0, v119
  v_fma_f32 v120, v97, 0, v120
  v_fma_f32 v119, v82, 0, v119
  v_fma_f32 v120, v98, 0, v120
  v_fma_f32 v119, v83, 0, v119
  v_fma_f32 v120, v99, 0, v120
  v_fma_f32 v119, v84, 0, v119
  v_fma_f32 v120, v100, 0, v120
  v_fma_f32 v119, v85, 0, v119
  v_fma_f32 v120, v101, 0, v120
  v_fma_f32 v119, v86, 0, v119
  v_fma_f32 v120, v102, 0, v120
  v_fma_f32 v119, v87, 0, v119
  v_fma_f32 v120, v103, 0, v120
  v_fma_f32 v119, v88, 0, v119
  v_fma_f32 v120, v104, 0, v120
  v_fma_f32 v119, v89, 0, v119
  v_fma_f32 v120, v105, 0, v120
  v_fma_f32 v119, v90, 0, v119
  v_fma_f32 v120, v106, 0, v120
  v_fma_f32 v119, v91, 0, v119
  v_fma_f32 v120, v107, 0, v120
  v_add_f32 v119, v119, v120
  v_cmp_neq_f32_e64 s[62:63], 0, v119
  v_min_f32 v121, v88, v104
  v_max_f32 v122, v88, v104
  v_mov_b32 v120, 0x1f800000
  v_cmp_nge_f32_e64 s[68:69], v121, v120
  v_mov_b32 v120, 0x5f000000
  v_cmp_nle_f32_e64 s[70:71], v122, v120
  s_nop 3
  s_or_b64 s[68:69], s[68:69], s[70:71]
  s_mov_b32 s68, 0
  s_or_b64 s[62:63], s[62:63], s[68:69]
  s_cmp_lg_u64 s[62:63], 0
  s_cselect_b32 s64, 1, 0
L_k2_9:
  s_cmp_eq_u32 s56, 1
  s_cbranch_scc1 L_k2_10
  ds_write_b128 v112, v[96:99] offset:0
  ds_write_b128 v112, v[100:103] offset:1024
  ds_write_b128 v112, v[104:107] offset:2048
  s_branch L_k2_11
L_k2_10:
  ds_write_b128 v112, v[80:83] offset:0
  ds_write_b128 v112, v[84:87] offset:1024
  ds_write_b128 v112, v[88:91] offset:2048
  s_waitcnt lgkmcnt(0)
  v_mov_b32 v80, v96
  v_mov_b32 v81, v97
  v_mov_b32 v82, v98
  v_mov_b32 v83, v99
  v_mov_b32 v84, v100
  v_mov_b32 v85, v101
  v_mov_b32 v86, v102
  v_mov_b32 v87, v103
  v_mov_b32 v88, v104
  v_mov_b32 v89, v105
  v_mov_b32 v90, v106
  v_mov_b32 v91, v107
L_k2_11:
  v_mov_b32 v120, s64
  s_lshl_b32 s63, s40, 2
  s_add_u32 s63, s63, 58112
  v_mov_b32 v121, s63
  ds_write_b32 v121, v120
  s_waitcnt lgkmcnt(0)
  s_barrier
  ds_read_b128 v[48:51], v113 offset:0
  ds_read_b128 v[52:55], v113 offset:1024
  ds_read_b128 v[56:59], v113 offset:2048
  v_and_b32 v121, 7, v1
  v_lshlrev_b32 v121, 2, v121
  v_add_u32 v121, 58112, v121
  ds_read_b32 v120, v121
  s_lshl_b32 s62, s54, 8
  s_lshl_b32 s63, s55, 6
  s_add_u32 s62, s62, s63
  s_lshl_b32 s63, s56, 5
  s_add_u32 s62, s62, s63
  v_add_u32 v114, s62, v18
  v_lshlrev_b32 v115, 4, v114
  s_add_u32 s32, s26, 0xee0000
  s_addc_u32 s33, s27, 0
  s_mov_b32 s34, 0x5e0000
  s_mov_b32 s35, 0x20000
  s_mul_i32 s62, s53, 20
  s_lshr_b32 s62, s62, 3
  s_and_b32 s64, s53, 1
  s_add_u32 s63, s62, s64
  s_lshl_b32 s63, s63, 15
  v_lshl_add_u32 v116, v19, 15, v115
  v_add_u32 v116, s63, v116
  s_add_u32 s63, s62, 2
  s_cmp_eq_u32 s64, 1
  s_cselect_b32 s63, s62, s63
  s_lshl_b32 s63, s63, 15
  s_lshl_b32 s62, s64, 3
  s_add_u32 s63, s63, s62
  v_add_u32 v117, s63, v115
  s_waitcnt lgkmcnt(0)
  v_cmp_ne_u32 vcc, 0, v120
  v_add_f32 v80, v80, v48
  v_add_f32 v81, v81, v49
  v_add_f32 v82, v82, v50
  v_add_f32 v83, v83, v51
  v_add_f32 v84, v84, v52
  v_add_f32 v85, v85, v53
  v_add_f32 v86, v86, v54
  v_add_f32 v87, v87, v55
  v_add_f32 v88, v88, v56
  v_add_f32 v89, v89, v57
  v_add_f32 v90, v90, v58
  v_add_f32 v91, v91, v59
  s_cbranch_vccnz L_at_fallback
  v_mov_b32 v121, v88
  v_mov_b32 v122, v88
  s_nop 1
  v_permlane32_swap_b32 v121, v122
  s_nop 1
  v_rcp_f32 v122, v122
  s_nop 0
  v_mul_f32 v122, v122, v127
  v_mul_f32 v80, v80, v122
  v_mul_f32 v81, v81, v122
  v_mul_f32 v82, v82, v122
  v_mul_f32 v83, v83, v122
  v_mul_f32 v84, v84, v122
  v_mul_f32 v85, v85, v122
  v_mul_f32 v86, v86, v122
  v_mul_f32 v87, v87, v122
  v_mul_f32 v88, v88, v122
  v_mul_f32 v89, v89, v122
  v_mul_f32 v90, v90, v122
  v_mul_f32 v91, v91, v122
  v_cvt_pk_bf16_f32 v68, v80, v81
  v_cvt_pk_bf16_f32 v69, v82, v83
  v_cvt_pk_bf16_f32 v70, v84, v85
  v_cvt_pk_bf16_f32 v71, v86, v87
  v_cvt_pk_bf16_f32 v72, v88, v89
  v_cvt_pk_bf16_f32 v73, v90, v91
  s_nop 0
  v_permlane32_swap_b32 v68, v70
  v_permlane32_swap_b32 v69, v71
  buffer_store_dwordx4 v[68:71], v116, s[32:35], 0 offen sc1
  s_mov_b32 exec_hi, 0
  buffer_store_dwordx2 v[72:73], v117, s[32:35], 0 offen sc1
  s_mov_b32 exec_hi, -1
  s_waitcnt vmcnt(0)
  s_add_u32 s32, s26, 0x1b00000
  s_addc_u32 s33, s27, 0
  s_mov_b32 s34, 0x6000
  s_mov_b32 s35, 0x20000
  s_lshl_b32 s62, s54, 10
  s_lshl_b32 s63, s53, 5
  s_add_u32 s62, s62, s63
  s_lshl_b32 s63, s40, 2
  s_add_u32 s62, s62, s63
  s_add_u32 s62, s62, 16384
  v_mov_b32 v2, 0
  v_mov_b32 v3, 1
  s_mov_b64 exec, 1
  buffer_store_dword v3, v2, s[32:35], s62 offen sc1
  s_mov_b64 exec, -1
  s_endpgm
L_at_fallback:
  s_barrier
  s_mov_b32 s44, s65
  s_mov_b32 s45, s66
  s_mov_b32 s46, s67
  s_mov_b32 s58, 0
  v_mov_b32 v124, 0xff800000
  v_mov_b32 v125, 0xff800000
  s_lshl_b32 s62, s56, 11
  v_lshlrev_b32 v112, 4, v18
  v_add_u32 v112, s62, v112
  s_movk_i32 s63, 4160
  v_mad_u32_u24 v14, v19, s63, v112
  v_add_u32 v15, 16640, v112
  v_mov_b32 v113, 20808
  v_cmp_eq_u32 vcc, 1, v19
  s_nop 1
  v_cndmask_b32 v15, v15, v113, vcc
  v_mov_b32 v116, 0x00003f80
  v_mov_b32 v117, 0x00000000
  v_mov_b32 v118, 0x3f803f80
  v_mov_b32 v119, 0x00003f80
  v_and_b32 v114, 255, v0
  v_lshlrev_b32 v114, 4, v114
  ds_write_b128 v114, v[116:119] offset:20800
  ds_write_b128 v114, v[116:119] offset:45760
  v_add_u32 v114, 49920, v114
  ds_write_b128 v114, v[116:119] offset:20800
  s_mov_b32 s52, 0
L_k2_12:
  s_mov_b32 s50, 0
  s_cmp_eq_u32 s58, 8
  s_cselect_b32 s59, 32768, 0
  s_cselect_b32 s58, 0, s58
  s_sub_u32 s44, s44, s59
  s_sub_u32 s45, s45, s59
  s_sub_u32 s46, s46, s59
  s_add_u32 s58, s58, 1
  s_add_u32 m0, s50, s47
  s_add_u32 s44, s44, 4096
  buffer_load_dwordx4 v17, s[28:31], s44 offen lds
  s_add_u32 m0, s50, s48
  s_add_u32 s45, s45, 4096
  buffer_load_dwordx4 v17, s[28:31], s45 offen lds
  s_add_u32 m0, s50, s49
  s_add_u32 s46, s46, 4096
  buffer_load_dwordx4 v17, s[28:31], s46 offen lds
  s_add_u32 s50, s50, 24960
  s_cmp_eq_u32 s50, 74880
  s_cselect_b32 s50, 0, s50
  s_waitcnt vmcnt(0) lgkmcnt(0)
  s_barrier
  ds_read_b128 v[20:23], v14 offset:0
  ds_read_b64 v[24:25], v15 offset:0
  s_waitcnt lgkmcnt(0)
  v_mfma_f32_32x32x16_bf16 v[48:63], v[20:23], v[2:5], 0
  v_mfma_f32_32x32x8_bf16 v[48:63], v[24:25], v[6:7], v[48:63]
  v_mfma_f32_32x32x16_bf16 v[64:79], v[20:23], v[8:11], 0
  v_mfma_f32_32x32x8_bf16 v[64:79], v[24:25], v[12:13], v[64:79]
  s_nop 15
  v_max3_f32 v124, v48, v49, v124
  v_max3_f32 v124, v50, v51, v124
  v_max3_f32 v124, v52, v53, v124
  v_max3_f32 v124, v54, v55, v124
  v_max3_f32 v124, v56, v57, v124
  v_max3_f32 v124, v58, v59, v124
  v_max3_f32 v124, v60, v61, v124
  v_max3_f32 v124, v62, v63, v124
  v_max3_f32 v125, v64, v65, v125
  v_max3_f32 v125, v66, v67, v125
  v_max3_f32 v125, v68, v69, v125
  v_max3_f32 v125, v70, v71, v125
  v_max3_f32 v125, v72, v73, v125
  v_max3_f32 v125, v74, v75, v125
  v_max3_f32 v125, v76, v77, v125
  v_max3_f32 v125, v78, v79, v125
  ds_read_b128 v[20:23], v14 offset:512
  ds_read_b64 v[24:25], v15 offset:512
  s_waitcnt lgkmcnt(0)
  v_mfma_f32_32x32x16_bf16 v[48:63], v[20:23], v[2:5], 0
  v_mfma_f32_32x32x8_bf16 v[48:63], v[24:25], v[6:7], v[48:63]
  v_mfma_f32_32x32x16_bf16 v[64:79], v[20:23], v[8:11], 0
  v_mfma_f32_32x32x8_bf16 v[64:79], v[24:25], v[12:13], v[64:79]
  s_nop 15
  v_max3_f32 v124, v48, v49, v124
  v_max3_f32 v124, v50, v51, v124
  v_max3_f32 v124, v52, v53, v124
  v_max3_f32 v124, v54, v55, v124
  v_max3_f32 v124, v56, v57, v124
  v_max3_f32 v124, v58, v59, v124
  v_max3_f32 v124, v60, v61, v124
  v_max3_f32 v124, v62, v63, v124
  v_max3_f32 v125, v64, v65, v125
  v_max3_f32 v125, v66, v67, v125
  v_max3_f32 v125, v68, v69, v125
  v_max3_f32 v125, v70, v71, v125
  v_max3_f32 v125, v72, v73, v125
  v_max3_f32 v125, v74, v75, v125
  v_max3_f32 v125, v76, v77, v125
  v_max3_f32 v125, v78, v79, v125
  ds_read_b128 v[20:23], v14 offset:1024
  ds_read_b64 v[24:25], v15 offset:1024
  s_waitcnt lgkmcnt(0)
  v_mfma_f32_32x32x16_bf16 v[48:63], v[20:23], v[2:5], 0
  v_mfma_f32_32x32x8_bf16 v[48:63], v[24:25], v[6:7], v[48:63]
  v_mfma_f32_32x32x16_bf16 v[64:79], v[20:23], v[8:11], 0
  v_mfma_f32_32x32x8_bf16 v[64:79], v[24:25], v[12:13], v[64:79]
  s_nop 15
  v_max3_f32 v124, v48, v49, v124
  v_max3_f32 v124, v50, v51, v124
  v_max3_f32 v124, v52, v53, v124
  v_max3_f32 v124, v54, v55, v124
  v_max3_f32 v124, v56, v57, v124
  v_max3_f32 v124, v58, v59, v124
  v_max3_f32 v124, v60, v61, v124
  v_max3_f32 v124, v62, v63, v124
  v_max3_f32 v125, v64, v65, v125
  v_max3_f32 v125, v66, v67, v125
  v_max3_f32 v125, v68, v69, v125
  v_max3_f32 v125, v70, v71, v125
  v_max3_f32 v125, v72, v73, v125
  v_max3_f32 v125, v74, v75, v125
  v_max3_f32 v125, v76, v77, v125
  v_max3_f32 v125, v78, v79, v125
  ds_read_b128 v[20:23], v14 offset:1536
  ds_read_b64 v[24:25], v15 offset:1536
  s_waitcnt lgkmcnt(0)
  v_mfma_f32_32x32x16_bf16 v[48:63], v[20:23], v[2:5], 0
  v_mfma_f32_32x32x8_bf16 v[48:63], v[24:25], v[6:7], v[48:63]
  v_mfma_f32_32x32x16_bf16 v[64:79], v[20:23], v[8:11], 0
  v_mfma_f32_32x32x8_bf16 v[64:79], v[24:25], v[12:13], v[64:79]
  s_nop 15
  v_max3_f32 v124, v48, v49, v124
  v_max3_f32 v124, v50, v51, v124
  v_max3_f32 v124, v52, v53, v124
  v_max3_f32 v124, v54, v55, v124
  v_max3_f32 v124, v56, v57, v124
  v_max3_f32 v124, v58, v59, v124
  v_max3_f32 v124, v60, v61, v124
  v_max3_f32 v124, v62, v63, v124
  v_max3_f32 v125, v64, v65, v125
  v_max3_f32 v125, v66, v67, v125
  v_max3_f32 v125, v68, v69, v125
  v_max3_f32 v125, v70, v71, v125
  v_max3_f32 v125, v72, v73, v125
  v_max3_f32 v125, v74, v75, v125
  v_max3_f32 v125, v76, v77, v125
  v_max3_f32 v125, v78, v79, v125
  s_barrier
  s_add_u32 s52, s52, 1
  s_cmp_lt_u32 s52, 8
  s_cbranch_scc1 L_k2_12
  v_mov_b32 v112, v124
  s_nop 1
  v_permlane32_swap_b32 v124, v112
  s_nop 1
  v_max_f32 v124, v124, v112
  v_mov_b32 v112, v125
  s_nop 1
  v_permlane32_swap_b32 v125, v112
  s_nop 1
  v_max_f32 v125, v125, v112
  s_lshl_b32 s62, s40, 9
  v_lshlrev_b32 v112, 2, v1
  v_add_u32 v113, s62, v112
  ds_write_b32 v113, v124
  ds_write_b32 v113, v125 offset:256
  s_waitcnt lgkmcnt(0)
  s_barrier
  s_xor_b32 s62, s40, 4
  s_lshl_b32 s62, s62, 9
  v_add_u32 v113, s62, v112
  ds_read_b32 v114, v113
  ds_read_b32 v115, v113 offset:256
  s_waitcnt lgkmcnt(0)
  v_max_f32 v124, v124, v114
  v_max_f32 v125, v125, v115
  v_cmp_eq_u32 vcc, 1, v19
  v_sub_f32 v124, 0, v124
  v_and_b32 v112, 0xffff0000, v124
  v_sub_f32 v113, v124, v112
  v_and_b32 v114, 0xffff0000, v113
  v_sub_f32 v113, v113, v114
  v_lshrrev_b32 v112, 16, v112
  v_or_b32 v112, v112, v114
  v_lshrrev_b32 v113, 16, v113
  v_cndmask_b32 v6, v6, v112, vcc
  v_cndmask_b32 v7, v7, v113, vcc
  v_sub_f32 v125, 0, v125
  v_and_b32 v112, 0xffff0000, v125
  v_sub_f32 v113, v125, v112
  v_and_b32 v114, 0xffff0000, v113
  v_sub_f32 v113, v113, v114
  v_lshrrev_b32 v112, 16, v112
  v_or_b32 v112, v112, v114
  v_lshrrev_b32 v113, 16, v113
  v_cndmask_b32 v12, v12, v112, vcc
  v_cndmask_b32 v13, v13, v113, vcc
  s_mov_b32 s57, 1
  s_barrier
  s_branch L_at_restart
L_k2_sp:
  s_setprio 3
  s_sub_u32 s60, s2, 256
  s_setprio 3
  s_add_u32 s28, s26, 0x1a80000
  s_addc_u32 s29, s27, 0
  s_mov_b32 s30, 0x6c000
  s_mov_b32 s31, 0x20000
  s_add_u32 s32, s26, 0x1700000
  s_addc_u32 s33, s27, 0
  s_mov_b32 s34, 0x360000
  s_mov_b32 s35, 0x20000
  s_add_u32 s36, s26, 0xb60000
  s_addc_u32 s37, s27, 0
  s_mov_b32 s38, 0x360000
  s_mov_b32 s39, 0x20000
  v_and_b32 v18, 7, v1
  v_lshrrev_b32 v19, 3, v1
  s_lshl_b32 s61, s60, 3
  v_add_u32 v2, s61, v18
  v_lshlrev_b32 v3, 3, v2
  v_lshl_add_u32 v3, v19, 14, v3
  s_mov_b32 s62, 0
  buffer_load_dwordx2 v[4:5], v3, s[28:31], s62 offen
  s_mov_b32 s62, 131072
  buffer_load_dwordx2 v[6:7], v3, s[28:31], s62 offen
  s_mov_b32 s62, 262144
  buffer_load_dwordx2 v[8:9], v3, s[28:31], s62 offen
  s_mov_b32 s62, 393216
  buffer_load_dwordx2 v[10:11], v3, s[28:31], s62 offen
  v_lshlrev_b32 v20, 4, v2
  v_lshl_add_u32 v20, v19, 15, v20
  s_lshl_b32 s63, s40, 18
  s_add_u32 s64, s63, 0
  buffer_load_dwordx4 v[24:27], v20, s[32:35], s64 offen
  s_add_u32 s64, s63, 2097152
  buffer_load_dwordx4 v[28:31], v20, s[32:35], s64 offen
  s_waitcnt vmcnt(2)
  v_add_f32 v4, v4, v6
  v_add_f32 v5, v5, v7
  v_add_f32 v4, v4, v8
  v_add_f32 v5, v5, v9
  v_add_f32 v4, v4, v10
  v_add_f32 v5, v5, v11
  s_nop 1
  v_add_f32 v4, v4, v4 row_ror:8
  v_add_f32 v5, v5, v5 row_ror:8
  v_mov_b32 v6, v4
  v_mov_b32 v7, v5
  s_nop 1
  v_permlane32_swap_b32 v4, v6
  v_permlane32_swap_b32 v5, v7
  s_nop 1
  v_add_f32 v4, v4, v6
  v_add_f32 v5, v5, v7
  v_mov_b32 v6, v4
  v_mov_b32 v7, v5
  s_nop 1
  v_permlane16_swap_b32 v4, v6
  v_permlane16_swap_b32 v5, v7
  s_nop 1
  v_add_f32 v4, v4, v6
  v_add_f32 v5, v5, v7
  s_mov_b32 s65, 0x3a97b426
  s_mov_b32 s66, 0x3727c5ac
  v_mul_f32 v4, s65, v4
  v_mul_f32 v5, s65, v5
  v_fma_f32 v5, -v4, v4, v5
  v_max_f32 v5, 0, v5
  v_add_f32 v5, s66, v5
  v_rsq_f32 v5, v5
  s_nop 0
  v_mul_f32 v4, v4, v5
  s_waitcnt vmcnt(1)
  v_lshlrev_b32 v6, 16, v24
  v_and_b32 v7, 0xffff0000, v24
  v_fma_f32 v6, v6, v5, -v4
  v_fma_f32 v7, v7, v5, -v4
  v_cvt_pk_bf16_f32 v24, v6, v7
  v_lshlrev_b32 v8, 16, v25
  v_and_b32 v9, 0xffff0000, v25
  v_fma_f32 v8, v8, v5, -v4
  v_fma_f32 v9, v9, v5, -v4
  v_cvt_pk_bf16_f32 v25, v8, v9
  v_lshlrev_b32 v6, 16, v26
  v_and_b32 v7, 0xffff0000, v26
  v_fma_f32 v6, v6, v5, -v4
  v_fma_f32 v7, v7, v5, -v4
  v_cvt_pk_bf16_f32 v26, v6, v7
  v_lshlrev_b32 v8, 16, v27
  v_and_b32 v9, 0xffff0000, v27
  v_fma_f32 v8, v8, v5, -v4
  v_fma_f32 v9, v9, v5, -v4
  v_cvt_pk_bf16_f32 v27, v8, v9
  s_add_u32 s64, s63, 0
  buffer_store_dwordx4 v[24:27], v20, s[36:39], s64 offen sc1
  s_waitcnt vmcnt(1)
  v_lshlrev_b32 v6, 16, v28
  v_and_b32 v7, 0xffff0000, v28
  v_fma_f32 v6, v6, v5, -v4
  v_fma_f32 v7, v7, v5, -v4
  v_cvt_pk_bf16_f32 v28, v6, v7
  v_lshlrev_b32 v8, 16, v29
  v_and_b32 v9, 0xffff0000, v29
  v_fma_f32 v8, v8, v5, -v4
  v_fma_f32 v9, v9, v5, -v4
  v_cvt_pk_bf16_f32 v29, v8, v9
  v_lshlrev_b32 v6, 16, v30
  v_and_b32 v7, 0xffff0000, v30
  v_fma_f32 v6, v6, v5, -v4
  v_fma_f32 v7, v7, v5, -v4
  v_cvt_pk_bf16_f32 v30, v6, v7
  v_lshlrev_b32 v8, 16, v31
  v_and_b32 v9, 0xffff0000, v31
  v_fma_f32 v8, v8, v5, -v4
  v_fma_f32 v9, v9, v5, -v4
  v_cvt_pk_bf16_f32 v31, v8, v9
  s_add_u32 s64, s63, 2097152
  buffer_store_dwordx4 v[28:31], v20, s[36:39], s64 offen sc1
  s_waitcnt vmcnt(0)
  s_barrier
  s_cmp_lg_u32 s40, 0
  s_cbranch_scc1 L_k2_14
  s_add_u32 s28, s26, 0x1b06000
  s_addc_u32 s29, s27, 0
  s_mov_b32 s30, 0x4000
  s_mov_b32 s31, 0x20000
  s_lshl_b32 s61, s60, 2
  v_lshlrev_b32 v2, 10, v1
  v_add_u32 v2, s61, v2
  v_mov_b32 v3, 1
  s_mov_b64 exec, 0xffff
  buffer_store_dword v3, v2, s[28:31], 0 offen sc1
  s_mov_b64 exec, -1
L_k2_14:
L_k2_13:
  s_sub_u32 s60, s2, 256
  s_and_b32 s61, s60, 7
  s_lshr_b32 s60, s60, 3
  s_lshl_b32 s44, s61, 2
  s_lshr_b32 s62, s60, 3
  s_add_u32 s44, s44, s62
  s_and_b32 s45, s60, 7
  s_lshr_b32 s62, s45, 1
  s_mul_i32 s62, s62, 27
  s_and_b32 s63, s45, 1
  s_mul_i32 s43, s63, 14
  s_add_u32 s43, s43, s62
  s_cmp_ge_u32 s40, 4
  s_cbranch_scc1 L_sp_prod
  v_and_b32 v18, 31, v1
  v_lshrrev_b32 v19, 5, v1
  v_bfe_u32 v22, v18, 1, 3
  v_xor_b32 v22, v22, v19
  v_lshlrev_b32 v22, 4, v22
  v_lshl_add_u32 v2, v18, 7, v22
  v_xor_b32 v3, 32, v2
  v_xor_b32 v4, 64, v2
  v_xor_b32 v5, 96, v2
  v_bfe_u32 v22, v1, 4, 1
  v_bfe_u32 v23, v1, 2, 2
  v_and_b32 v24, 3, v1
  v_lshrrev_b32 v25, 1, v24
  v_lshl_add_u32 v25, v22, 1, v25
  s_lshl_b32 s46, s40, 2
  v_add_u32 v25, s46, v25
  v_mul_u32_u24 v25, 1088, v25
  v_lshl_add_u32 v26, v19, 3, v23
  v_lshl_add_u32 v25, v26, 4, v25
  v_and_b32 v24, 1, v24
  v_lshl_add_u32 v25, v24, 3, v25
  v_add_u32 v6, 8192, v25
  s_lshl_b32 s46, s44, 6
  v_add_u32 v9, s46, v18
  s_add_u32 s60, s26, 0xec0000
  s_addc_u32 s61, s27, 0
  s_mov_b32 s62, 0x2000
  s_mov_b32 s63, 0x20000
  v_lshlrev_b32 v10, 2, v9
  buffer_load_dword v11, v10, s[60:63], 0 offen
  buffer_load_dword v15, v10, s[60:63], 0 offen offset:128
  s_mov_b32 s60, s16
  s_mov_b32 s61, s17
  s_mov_b32 s62, 0x1000
  s_mov_b32 s63, 0x20000
  v_lshlrev_b32 v10, 1, v9
  buffer_load_ushort v12, v10, s[60:63], 0 offen
  buffer_load_ushort v16, v10, s[60:63], 0 offen offset:64
  s_add_u32 s60, s26, 0x800000
  s_addc_u32 s61, s27, 0
  s_mov_b32 s62, 0x360000
  s_mov_b32 s63, 0x20000
  v_lshlrev_b32 v10, 4, v9
  v_lshl_add_u32 v13, v19, 3, v10
  v_lshl_add_u32 v14, v19, 15, v10
  s_lshl_b32 s46, s40, 2
  s_add_u32 s46, s46, s43
  s_lshl_b32 s46, s46, 15
  s_add_u32 s47, s46, 0
  buffer_load_dwordx2 v[96:97], v13, s[60:63], s47 offen offset:0
  buffer_load_dwordx2 v[104:105], v13, s[60:63], s47 offen offset:512
  s_add_u32 s47, s46, 32768
  buffer_load_dwordx2 v[98:99], v13, s[60:63], s47 offen offset:0
  buffer_load_dwordx2 v[106:107], v13, s[60:63], s47 offen offset:512
  s_add_u32 s47, s46, 65536
  buffer_load_dwordx2 v[100:101], v13, s[60:63], s47 offen offset:0
  buffer_load_dwordx2 v[108:109], v13, s[60:63], s47 offen offset:512
  s_add_u32 s47, s46, 98304
  buffer_load_dwordx2 v[102:103], v13, s[60:63], s47 offen offset:0
  buffer_load_dwordx2 v[110:111], v13, s[60:63], s47 offen offset:512
  v_mov_b32 v64, 0
  v_mov_b32 v65, 0
  v_mov_b32 v66, 0
  v_mov_b32 v67, 0
  v_mov_b32 v68, 0
  v_mov_b32 v69, 0
  v_mov_b32 v70, 0
  v_mov_b32 v71, 0
  v_mov_b32 v72, 0
  v_mov_b32 v73, 0
  v_mov_b32 v74, 0
  v_mov_b32 v75, 0
  v_mov_b32 v76, 0
  v_mov_b32 v77, 0
  v_mov_b32 v78, 0
  v_mov_b32 v79, 0
  v_mov_b32 v80, 0
  v_mov_b32 v81, 0
  v_mov_b32 v82, 0
  v_mov_b32 v83, 0
  v_mov_b32 v84, 0
  v_mov_b32 v85, 0
  v_mov_b32 v86, 0
  v_mov_b32 v87, 0
  v_mov_b32 v88, 0
  v_mov_b32 v89, 0
  v_mov_b32 v90, 0
  v_mov_b32 v91, 0
  v_mov_b32 v92, 0
  v_mov_b32 v93, 0
  v_mov_b32 v94, 0
  v_mov_b32 v95, 0
  s_setprio 0
  s_barrier
  s_barrier
  s_mov_b32 s47, 0
L_k2_15:
  ds_read_b64_tr_b16 v[48:49], v6 offset:0
  ds_read_b64_tr_b16 v[50:51], v6 offset:64
  ds_read_b128 v[32:35], v2 offset:0
  ds_read_b128 v[36:39], v2 offset:4096
  ds_read_b64_tr_b16 v[52:53], v6 offset:256
  ds_read_b64_tr_b16 v[54:55], v6 offset:320
  ds_read_b128 v[40:43], v3 offset:0
  ds_read_b128 v[44:47], v3 offset:4096
  s_waitcnt lgkmcnt(4)
  v_mfma_f32_32x32x16_bf16 v[64:79], v[48:51], v[32:35], v[64:79]
  v_mfma_f32_32x32x16_bf16 v[80:95], v[48:51], v[36:39], v[80:95]
  ds_read_b64_tr_b16 v[48:49], v6 offset:512
  ds_read_b64_tr_b16 v[50:51], v6 offset:576
  ds_read_b128 v[32:35], v4 offset:0
  ds_read_b128 v[36:39], v4 offset:4096
  s_waitcnt lgkmcnt(4)
  v_mfma_f32_32x32x16_bf16 v[64:79], v[52:55], v[40:43], v[64:79]
  v_mfma_f32_32x32x16_bf16 v[80:95], v[52:55], v[44:47], v[80:95]
  ds_read_b64_tr_b16 v[52:53], v6 offset:768
  ds_read_b64_tr_b16 v[54:55], v6 offset:832
  ds_read_b128 v[40:43], v5 offset:0
  ds_read_b128 v[44:47], v5 offset:4096
  s_waitcnt lgkmcnt(4)
  v_mfma_f32_32x32x16_bf16 v[64:79], v[48:51], v[32:35], v[64:79]
  v_mfma_f32_32x32x16_bf16 v[80:95], v[48:51], v[36:39], v[80:95]
  s_waitcnt lgkmcnt(0)
  v_mfma_f32_32x32x16_bf16 v[64:79], v[52:55], v[40:43], v[64:79]
  v_mfma_f32_32x32x16_bf16 v[80:95], v[52:55], v[44:47], v[80:95]
  s_barrier
  ds_read_b64_tr_b16 v[48:49], v6 offset:25600
  ds_read_b64_tr_b16 v[50:51], v6 offset:25664
  ds_read_b128 v[32:35], v2 offset:25600
  ds_read_b128 v[36:39], v2 offset:29696
  ds_read_b64_tr_b16 v[52:53], v6 offset:25856
  ds_read_b64_tr_b16 v[54:55], v6 offset:25920
  ds_read_b128 v[40:43], v3 offset:25600
  ds_read_b128 v[44:47], v3 offset:29696
  s_waitcnt lgkmcnt(4)
  v_mfma_f32_32x32x16_bf16 v[64:79], v[48:51], v[32:35], v[64:79]
  v_mfma_f32_32x32x16_bf16 v[80:95], v[48:51], v[36:39], v[80:95]
  ds_read_b64_tr_b16 v[48:49], v6 offset:26112
  ds_read_b64_tr_b16 v[50:51], v6 offset:26176
  ds_read_b128 v[32:35], v4 offset:25600
  ds_read_b128 v[36:39], v4 offset:29696
  s_waitcnt lgkmcnt(4)
  v_mfma_f32_32x32x16_bf16 v[64:79], v[52:55], v[40:43], v[64:79]
  v_mfma_f32_32x32x16_bf16 v[80:95], v[52:55], v[44:47], v[80:95]
  ds_read_b64_tr_b16 v[52:53], v6 offset:26368
  ds_read_b64_tr_b16 v[54:55], v6 offset:26432
  ds_read_b128 v[40:43], v5 offset:25600
  ds_read_b128 v[44:47], v5 offset:29696
  s_waitcnt lgkmcnt(4)
  v_mfma_f32_32x32x16_bf16 v[64:79], v[48:51], v[32:35], v[64:79]
  v_mfma_f32_32x32x16_bf16 v[80:95], v[48:51], v[36:39], v[80:95]
  s_waitcnt lgkmcnt(0)
  v_mfma_f32_32x32x16_bf16 v[64:79], v[52:55], v[40:43], v[64:79]
  v_mfma_f32_32x32x16_bf16 v[80:95], v[52:55], v[44:47], v[80:95]
  s_barrier
  ds_read_b64_tr_b16 v[48:49], v6 offset:51200
  ds_read_b64_tr_b16 v[50:51], v6 offset:51264
  ds_read_b128 v[32:35], v2 offset:51200
  ds_read_b128 v[36:39], v2 offset:55296
  ds_read_b64_tr_b16 v[52:53], v6 offset:51456
  ds_read_b64_tr_b16 v[54:55], v6 offset:51520
  ds_read_b128 v[40:43], v3 offset:51200
  ds_read_b128 v[44:47], v3 offset:55296
  s_waitcnt lgkmcnt(4)
  v_mfma_f32_32x32x16_bf16 v[64:79], v[48:51], v[32:35], v[64:79]
  v_mfma_f32_32x32x16_bf16 v[80:95], v[48:51], v[36:39], v[80:95]
  ds_read_b64_tr_b16 v[48:49], v6 offset:51712
  ds_read_b64_tr_b16 v[50:51], v6 offset:51776
  ds_read_b128 v[32:35], v4 offset:51200
  ds_read_b128 v[36:39], v4 offset:55296
  s_waitcnt lgkmcnt(4)
  v_mfma_f32_32x32x16_bf16 v[64:79], v[52:55], v[40:43], v[64:79]
  v_mfma_f32_32x32x16_bf16 v[80:95], v[52:55], v[44:47], v[80:95]
  ds_read_b64_tr_b16 v[52:53], v6 offset:51968
  ds_read_b64_tr_b16 v[54:55], v6 offset:52032
  ds_read_b128 v[40:43], v5 offset:51200
  ds_read_b128 v[44:47], v5 offset:55296
  s_waitcnt lgkmcnt(4)
  v_mfma_f32_32x32x16_bf16 v[64:79], v[48:51], v[32:35], v[64:79]
  v_mfma_f32_32x32x16_bf16 v[80:95], v[48:51], v[36:39], v[80:95]
  s_waitcnt lgkmcnt(0)
  v_mfma_f32_32x32x16_bf16 v[64:79], v[52:55], v[40:43], v[64:79]
  v_mfma_f32_32x32x16_bf16 v[80:95], v[52:55], v[44:47], v[80:95]
  s_barrier
  s_add_u32 s47, s47, 1
  s_cmp_lt_u32 s47, 10
  s_cbranch_scc1 L_k2_15
  ds_read_b64_tr_b16 v[48:49], v6 offset:0
  ds_read_b64_tr_b16 v[50:51], v6 offset:64
  ds_read_b128 v[32:35], v2 offset:0
  ds_read_b128 v[36:39], v2 offset:4096
  ds_read_b64_tr_b16 v[52:53], v6 offset:256
  ds_read_b64_tr_b16 v[54:55], v6 offset:320
  ds_read_b128 v[40:43], v3 offset:0
  ds_read_b128 v[44:47], v3 offset:4096
  s_waitcnt lgkmcnt(4)
  v_mfma_f32_32x32x16_bf16 v[64:79], v[48:51], v[32:35], v[64:79]
  v_mfma_f32_32x32x16_bf16 v[80:95], v[48:51], v[36:39], v[80:95]
  ds_read_b64_tr_b16 v[48:49], v6 offset:512
  ds_read_b64_tr_b16 v[50:51], v6 offset:576
  ds_read_b128 v[32:35], v4 offset:0
  ds_read_b128 v[36:39], v4 offset:4096
  s_waitcnt lgkmcnt(4)
  v_mfma_f32_32x32x16_bf16 v[64:79], v[52:55], v[40:43], v[64:79]
  v_mfma_f32_32x32x16_bf16 v[80:95], v[52:55], v[44:47], v[80:95]
  ds_read_b64_tr_b16 v[52:53], v6 offset:768
  ds_read_b64_tr_b16 v[54:55], v6 offset:832
  ds_read_b128 v[40:43], v5 offset:0
  ds_read_b128 v[44:47], v5 offset:4096
  s_waitcnt lgkmcnt(4)
  v_mfma_f32_32x32x16_bf16 v[64:79], v[48:51], v[32:35], v[64:79]
  v_mfma_f32_32x32x16_bf16 v[80:95], v[48:51], v[36:39], v[80:95]
  s_waitcnt lgkmcnt(0)
  v_mfma_f32_32x32x16_bf16 v[64:79], v[52:55], v[40:43], v[64:79]
  v_mfma_f32_32x32x16_bf16 v[80:95], v[52:55], v[44:47], v[80:95]
  s_barrier
  ds_read_b64_tr_b16 v[48:49], v6 offset:25600
  ds_read_b64_tr_b16 v[50:51], v6 offset:25664
  ds_read_b128 v[32:35], v2 offset:25600
  ds_read_b128 v[36:39], v2 offset:29696
  ds_read_b64_tr_b16 v[52:53], v6 offset:25856
  ds_read_b64_tr_b16 v[54:55], v6 offset:25920
  ds_read_b128 v[40:43], v3 offset:25600
  ds_read_b128 v[44:47], v3 offset:29696
  s_waitcnt lgkmcnt(4)
  v_mfma_f32_32x32x16_bf16 v[64:79], v[48:51], v[32:35], v[64:79]
  v_mfma_f32_32x32x16_bf16 v[80:95], v[48:51], v[36:39], v[80:95]
  ds_read_b64_tr_b16 v[48:49], v6 offset:26112
  ds_read_b64_tr_b16 v[50:51], v6 offset:26176
  ds_read_b128 v[32:35], v4 offset:25600
  ds_read_b128 v[36:39], v4 offset:29696
  s_waitcnt lgkmcnt(4)
  v_mfma_f32_32x32x16_bf16 v[64:79], v[52:55], v[40:43], v[64:79]
  v_mfma_f32_32x32x16_bf16 v[80:95], v[52:55], v[44:47], v[80:95]
  ds_read_b64_tr_b16 v[52:53], v6 offset:26368
  ds_read_b64_tr_b16 v[54:55], v6 offset:26432
  ds_read_b128 v[40:43], v5 offset:25600
  ds_read_b128 v[44:47], v5 offset:29696
  s_waitcnt lgkmcnt(4)
  v_mfma_f32_32x32x16_bf16 v[64:79], v[48:51], v[32:35], v[64:79]
  v_mfma_f32_32x32x16_bf16 v[80:95], v[48:51], v[36:39], v[80:95]
  s_waitcnt lgkmcnt(0)
  v_mfma_f32_32x32x16_bf16 v[64:79], v[52:55], v[40:43], v[64:79]
  v_mfma_f32_32x32x16_bf16 v[80:95], v[52:55], v[44:47], v[80:95]
  s_barrier
  s_setprio 3
  s_waitcnt vmcnt(0)
  v_lshlrev_b32 v12, 16, v12
  v_lshlrev_b32 v16, 16, v16
  v_sub_f32 v11, 1.0, v11
  v_sub_f32 v15, 1.0, v15
  s_nop 11
  v_add_f32 v64, v64, v12
  v_add_f32 v65, v65, v12
  v_add_f32 v66, v66, v12
  v_add_f32 v67, v67, v12
  v_add_f32 v68, v68, v12
  v_add_f32 v69, v69, v12
  v_add_f32 v70, v70, v12
  v_add_f32 v71, v71, v12
  v_add_f32 v72, v72, v12
  v_add_f32 v73, v73, v12
  v_add_f32 v74, v74, v12
  v_add_f32 v75, v75, v12
  v_add_f32 v76, v76, v12
  v_add_f32 v77, v77, v12
  v_add_f32 v78, v78, v12
  v_add_f32 v79, v79, v12
  v_mul_f32 v64, v64, v11
  v_mul_f32 v65, v65, v11
  v_mul_f32 v66, v66, v11
  v_mul_f32 v67, v67, v11
  v_mul_f32 v68, v68, v11
  v_mul_f32 v69, v69, v11
  v_mul_f32 v70, v70, v11
  v_mul_f32 v71, v71, v11
  v_mul_f32 v72, v72, v11
  v_mul_f32 v73, v73, v11
  v_mul_f32 v74, v74, v11
  v_mul_f32 v75, v75, v11
  v_mul_f32 v76, v76, v11
  v_mul_f32 v77, v77, v11
  v_mul_f32 v78, v78, v11
  v_mul_f32 v79, v79, v11
  v_lshlrev_b32 v40, 16, v96
  v_and_b32 v41, 0xffff0000, v96
  v_mul_f32 v64, v64, v40
  v_mul_f32 v65, v65, v41
  v_lshlrev_b32 v40, 16, v97
  v_and_b32 v41, 0xffff0000, v97
  v_mul_f32 v66, v66, v40
  v_mul_f32 v67, v67, v41
  v_lshlrev_b32 v40, 16, v98
  v_and_b32 v41, 0xffff0000, v98
  v_mul_f32 v68, v68, v40
  v_mul_f32 v69, v69, v41
  v_lshlrev_b32 v40, 16, v99
  v_and_b32 v41, 0xffff0000, v99
  v_mul_f32 v70, v70, v40
  v_mul_f32 v71, v71, v41
  v_lshlrev_b32 v40, 16, v100
  v_and_b32 v41, 0xffff0000, v100
  v_mul_f32 v72, v72, v40
  v_mul_f32 v73, v73, v41
  v_lshlrev_b32 v40, 16, v101
  v_and_b32 v41, 0xffff0000, v101
  v_mul_f32 v74, v74, v40
  v_mul_f32 v75, v75, v41
  v_lshlrev_b32 v40, 16, v102
  v_and_b32 v41, 0xffff0000, v102
  v_mul_f32 v76, v76, v40
  v_mul_f32 v77, v77, v41
  v_lshlrev_b32 v40, 16, v103
  v_and_b32 v41, 0xffff0000, v103
  v_mul_f32 v78, v78, v40
  v_mul_f32 v79, v79, v41
  v_add_f32 v80, v80, v16
  v_add_f32 v81, v81, v16
  v_add_f32 v82, v82, v16
  v_add_f32 v83, v83, v16
  v_add_f32 v84, v84, v16
  v_add_f32 v85, v85, v16
  v_add_f32 v86, v86, v16
  v_add_f32 v87, v87, v16
  v_add_f32 v88, v88, v16
  v_add_f32 v89, v89, v16
  v_add_f32 v90, v90, v16
  v_add_f32 v91, v91, v16
  v_add_f32 v92, v92, v16
  v_add_f32 v93, v93, v16
  v_add_f32 v94, v94, v16
  v_add_f32 v95, v95, v16
  v_mul_f32 v80, v80, v15
  v_mul_f32 v81, v81, v15
  v_mul_f32 v82, v82, v15
  v_mul_f32 v83, v83, v15
  v_mul_f32 v84, v84, v15
  v_mul_f32 v85, v85, v15
  v_mul_f32 v86, v86, v15
  v_mul_f32 v87, v87, v15
  v_mul_f32 v88, v88, v15
  v_mul_f32 v89, v89, v15
  v_mul_f32 v90, v90, v15
  v_mul_f32 v91, v91, v15
  v_mul_f32 v92, v92, v15
  v_mul_f32 v93, v93, v15
  v_mul_f32 v94, v94, v15
  v_mul_f32 v95, v95, v15
  v_lshlrev_b32 v40, 16, v104
  v_and_b32 v41, 0xffff0000, v104
  v_mul_f32 v80, v80, v40
  v_mul_f32 v81, v81, v41
  v_lshlrev_b32 v40, 16, v105
  v_and_b32 v41, 0xffff0000, v105
  v_mul_f32 v82, v82, v40
  v_mul_f32 v83, v83, v41
  v_lshlrev_b32 v40, 16, v106
  v_and_b32 v41, 0xffff0000, v106
  v_mul_f32 v84, v84, v40
  v_mul_f32 v85, v85, v41
  v_lshlrev_b32 v40, 16, v107
  v_and_b32 v41, 0xffff0000, v107
  v_mul_f32 v86, v86, v40
  v_mul_f32 v87, v87, v41
  v_lshlrev_b32 v40, 16, v108
  v_and_b32 v41, 0xffff0000, v108
  v_mul_f32 v88, v88, v40
  v_mul_f32 v89, v89, v41
  v_lshlrev_b32 v40, 16, v109
  v_and_b32 v41, 0xffff0000, v109
  v_mul_f32 v90, v90, v40
  v_mul_f32 v91, v91, v41
  v_lshlrev_b32 v40, 16, v110
  v_and_b32 v41, 0xffff0000, v110
  v_mul_f32 v92, v92, v40
  v_mul_f32 v93, v93, v41
  v_lshlrev_b32 v40, 16, v111
  v_and_b32 v41, 0xffff0000, v111
  v_mul_f32 v94, v94, v40
  v_mul_f32 v95, v95, v41
  s_add_u32 s36, s26, 0xee0000
  s_addc_u32 s37, s27, 0
  s_mov_b32 s38, 0x5e0000
  s_mov_b32 s39, 0x20000
  s_lshl_b32 s46, s40, 2
  s_add_u32 s46, s46, s43
  s_add_u32 s46, s46, 80
  s_lshl_b32 s46, s46, 15
  v_cvt_pk_bf16_f32 v44, v64, v65
  v_cvt_pk_bf16_f32 v45, v66, v67
  v_cvt_pk_bf16_f32 v46, v68, v69
  v_cvt_pk_bf16_f32 v47, v70, v71
  v_cvt_pk_bf16_f32 v48, v72, v73
  v_cvt_pk_bf16_f32 v49, v74, v75
  v_cvt_pk_bf16_f32 v50, v76, v77
  v_cvt_pk_bf16_f32 v51, v78, v79
  v_cvt_pk_bf16_f32 v52, v80, v81
  v_cvt_pk_bf16_f32 v53, v82, v83
  v_cvt_pk_bf16_f32 v54, v84, v85
  v_cvt_pk_bf16_f32 v55, v86, v87
  v_cvt_pk_bf16_f32 v56, v88, v89
  v_cvt_pk_bf16_f32 v57, v90, v91
  v_cvt_pk_bf16_f32 v58, v92, v93
  v_cvt_pk_bf16_f32 v59, v94, v95
  s_nop 1
  v_permlane32_swap_b32 v44, v46
  v_permlane32_swap_b32 v45, v47
  v_permlane32_swap_b32 v48, v50
  v_permlane32_swap_b32 v49, v51
  v_permlane32_swap_b32 v52, v54
  v_permlane32_swap_b32 v53, v55
  v_permlane32_swap_b32 v56, v58
  v_permlane32_swap_b32 v57, v59
  s_cmp_eq_u32 s40, 3
  s_cselect_b32 s48, 1, 0
  s_and_b32 s49, s48, s45
  s_and_b32 s49, s49, 1
  s_cmp_eq_u32 s49, 1
  s_cselect_b32 exec_hi, 0, -1
  buffer_store_dwordx4 v[44:47], v14, s[36:39], s46 offen offset:0 sc1
  buffer_store_dwordx4 v[52:55], v14, s[36:39], s46 offen offset:512 sc1
  s_mov_b32 exec_hi, -1
  s_cmp_eq_u32 s48, 1
  s_cbranch_scc1 L_k2_16
  s_add_u32 s47, s46, 65536
  buffer_store_dwordx4 v[48:51], v14, s[36:39], s47 offen offset:0 sc1
  buffer_store_dwordx4 v[56:59], v14, s[36:39], s47 offen offset:512 sc1
L_k2_16:
  s_waitcnt vmcnt(0)
  s_add_u32 s60, s26, 0x1b00000
  s_addc_u32 s61, s27, 0
  s_mov_b32 s62, 0x6000
  s_mov_b32 s63, 0x20000
  s_lshl_b32 s50, s44, 7
  s_lshl_b32 s51, s45, 4
  s_add_u32 s47, s50, s51
  s_lshl_b32 s51, s40, 2
  s_add_u32 s47, s47, s51
  s_add_u32 s47, s47, 8192
  v_mov_b32 v2, 0
  v_mov_b32 v3, 1
  s_mov_b64 exec, 1
  buffer_store_dword v3, v2, s[60:63], s47 offen sc1
  s_mov_b64 exec, -1
  s_branch L_F
  s_endpgm
L_sp_prod:
  s_sub_u32 s46, s40, 4
  s_mov_b32 s28, s14
  s_mov_b32 s29, s15
  s_mov_b32 s30, 0x800000
  s_mov_b32 s31, 0x20000
  s_add_u32 s32, s26, 0xb60000
  s_addc_u32 s33, s27, 0
  s_mov_b32 s34, 0x360000
  s_mov_b32 s35, 0x20000
  v_lshrrev_b32 v20, 3, v1
  v_lshlrev_b32 v20, 12, v20
  s_and_b32 s47, s46, 1
  s_lshl_b32 s47, s47, 2
  v_lshrrev_b32 v17, 4, v1
  v_add_u32 v21, s47, v17
  v_and_b32 v21, 7, v21
  v_and_b32 v22, 7, v1
  v_xor_b32 v21, v21, v22
  v_lshl_add_u32 v7, v21, 4, v20
  v_lshlrev_b32 v8, 4, v1
  s_lshl_b32 s47, s44, 6
  s_lshl_b32 s48, s46, 3
  s_add_u32 s47, s47, s48
  s_lshl_b32 s48, s47, 12
  s_sub_u32 s48, s48, 128
  s_add_u32 s49, s48, 131072
  s_add_u32 s47, s43, s46
  s_lshl_b32 s52, s47, 15
  s_sub_u32 s52, s52, 1024
  s_add_u32 s53, s52, 131072
  s_add_u32 s54, s53, 131072
  s_add_u32 s55, s54, 131072
  s_and_b32 s47, s45, 1
  s_add_u32 s47, s47, s46
  s_cmp_ge_u32 s47, 2
  s_cselect_b32 s55, 0x7f000000, s55
  s_lshl_b32 s56, s46, 10
  s_mul_i32 s57, s46, 1088
  s_add_u32 s57, s57, 8192
  s_add_u32 s59, s56, 0
  s_add_u32 m0, s59, 0
  s_add_u32 s48, s48, 128
  buffer_load_dwordx4 v7, s[28:31], s48 offen lds
  s_add_u32 s59, s56, 0
  s_add_u32 m0, s59, 4096
  s_add_u32 s49, s49, 128
  buffer_load_dwordx4 v7, s[28:31], s49 offen lds
  s_add_u32 s59, s56, 25600
  s_add_u32 m0, s59, 0
  s_add_u32 s48, s48, 128
  buffer_load_dwordx4 v7, s[28:31], s48 offen lds
  s_add_u32 s59, s56, 25600
  s_add_u32 m0, s59, 4096
  s_add_u32 s49, s49, 128
  buffer_load_dwordx4 v7, s[28:31], s49 offen lds
  s_add_u32 s59, s56, 51200
  s_add_u32 m0, s59, 0
  s_add_u32 s48, s48, 128
  buffer_load_dwordx4 v7, s[28:31], s48 offen lds
  s_add_u32 s59, s56, 51200
  s_add_u32 m0, s59, 4096
  s_add_u32 s49, s49, 128
  buffer_load_dwordx4 v7, s[28:31], s49 offen lds
  s_cmp_lg_u32 s46, 0
  s_cbranch_scc1 L_k2_17
  s_add_u32 s60, s26, 0x1b06000
  s_addc_u32 s61, s27, 0
  s_mov_b32 s62, 0x4000
  s_mov_b32 s63, 0x20000
  s_and_b32 s58, s2, 15
  s_lshl_b32 s58, s58, 10
  v_lshlrev_b32 v26, 4, v1
  s_mov_b32 s47, 0
L_k2_18:
  buffer_load_dwordx4 v[28:31], v26, s[60:63], s58 offen sc1
  s_waitcnt vmcnt(0)
  v_and_b32 v28, v28, v29
  v_and_b32 v30, v30, v31
  v_and_b32 v28, v28, v30
  v_cmp_ne_u32 vcc, 0, v28
  s_add_u32 s47, s47, 1
  s_nop 3
  s_cmp_eq_u64 vcc, -1
  s_cbranch_scc1 L_k2_19
  s_sleep 4
  s_cmp_lt_u32 s47, 0x40000
  s_cbranch_scc1 L_k2_18
L_k2_19:
L_k2_17:
  s_barrier
  s_add_u32 s59, s57, 0
  s_add_u32 m0, s59, 0
  s_add_u32 s52, s52, 1024
  buffer_load_dwordx4 v8, s[32:35], s52 offen sc1 lds
  s_add_u32 s59, s57, 0
  s_add_u32 m0, s59, 4352
  s_add_u32 s53, s53, 1024
  buffer_load_dwordx4 v8, s[32:35], s53 offen sc1 lds
  s_add_u32 s59, s57, 0
  s_add_u32 m0, s59, 8704
  s_add_u32 s54, s54, 1024
  buffer_load_dwordx4 v8, s[32:35], s54 offen sc1 lds
  s_add_u32 s59, s57, 0
  s_add_u32 m0, s59, 13056
  s_add_u32 s55, s55, 1024
  buffer_load_dwordx4 v8, s[32:35], s55 offen sc1 lds
  s_add_u32 s59, s57, 25600
  s_add_u32 m0, s59, 0
  s_add_u32 s52, s52, 1024
  buffer_load_dwordx4 v8, s[32:35], s52 offen sc1 lds
  s_add_u32 s59, s57, 25600
  s_add_u32 m0, s59, 4352
  s_add_u32 s53, s53, 1024
  buffer_load_dwordx4 v8, s[32:35], s53 offen sc1 lds
  s_add_u32 s59, s57, 25600
  s_add_u32 m0, s59, 8704
  s_add_u32 s54, s54, 1024
  buffer_load_dwordx4 v8, s[32:35], s54 offen sc1 lds
  s_add_u32 s59, s57, 25600
  s_add_u32 m0, s59, 13056
  s_add_u32 s55, s55, 1024
  buffer_load_dwordx4 v8, s[32:35], s55 offen sc1 lds
  s_add_u32 s59, s57, 51200
  s_add_u32 m0, s59, 0
  s_add_u32 s52, s52, 1024
  buffer_load_dwordx4 v8, s[32:35], s52 offen sc1 lds
  s_add_u32 s59, s57, 51200
  s_add_u32 m0, s59, 4352
  s_add_u32 s53, s53, 1024
  buffer_load_dwordx4 v8, s[32:35], s53 offen sc1 lds
  s_add_u32 s59, s57, 51200
  s_add_u32 m0, s59, 8704
  s_add_u32 s54, s54, 1024
  buffer_load_dwordx4 v8, s[32:35], s54 offen sc1 lds
  s_add_u32 s59, s57, 51200
  s_add_u32 m0, s59, 13056
  s_add_u32 s55, s55, 1024
  buffer_load_dwordx4 v8, s[32:35], s55 offen sc1 lds
  s_setprio 0
  s_waitcnt vmcnt(8)
  s_barrier
  s_mov_b32 s47, 0
  s_mov_b32 s58, 0
L_k2_20:
  s_cmp_ge_u32 s47, 30
  s_cbranch_scc1 L_k2_21
  s_cmp_eq_u32 s47, 0
  s_cbranch_scc1 L_k2_22
  s_waitcnt vmcnt(6)
  s_branch L_k2_23
L_k2_21:
  s_waitcnt vmcnt(0)
L_k2_22:
  s_waitcnt vmcnt(4)
L_k2_23:
  s_barrier
  s_cmp_ge_u32 s47, 29
  s_cbranch_scc1 L_k2_24
  s_add_u32 s59, s56, s58
  s_add_u32 m0, s59, 0
  s_add_u32 s48, s48, 128
  buffer_load_dwordx4 v7, s[28:31], s48 offen lds
  s_add_u32 s59, s56, s58
  s_add_u32 m0, s59, 4096
  s_add_u32 s49, s49, 128
  buffer_load_dwordx4 v7, s[28:31], s49 offen lds
  s_add_u32 s59, s57, s58
  s_add_u32 m0, s59, 0
  s_add_u32 s52, s52, 1024
  buffer_load_dwordx4 v8, s[32:35], s52 offen sc1 lds
  s_add_u32 s59, s57, s58
  s_add_u32 m0, s59, 4352
  s_add_u32 s53, s53, 1024
  buffer_load_dwordx4 v8, s[32:35], s53 offen sc1 lds
  s_add_u32 s59, s57, s58
  s_add_u32 m0, s59, 8704
  s_add_u32 s54, s54, 1024
  buffer_load_dwordx4 v8, s[32:35], s54 offen sc1 lds
  s_add_u32 s59, s57, s58
  s_add_u32 m0, s59, 13056
  s_add_u32 s55, s55, 1024
  buffer_load_dwordx4 v8, s[32:35], s55 offen sc1 lds
L_k2_24:
  s_add_u32 s58, s58, 25600
  s_cmp_eq_u32 s58, 76800
  s_cselect_b32 s58, 0, s58
  s_add_u32 s47, s47, 1
  s_cmp_lt_u32 s47, 31
  s_cbranch_scc1 L_k2_20
  s_barrier
  s_add_u32 s28, s26, 0xee0000
  s_addc_u32 s29, s27, 0
  s_mov_b32 s30, 0x5e0000
  s_mov_b32 s31, 0x20000
  s_add_u32 s32, s26, 0x14c0000
  s_addc_u32 s33, s27, 0
  s_mov_b32 s34, 0x1d6000
  s_mov_b32 s35, 0x20000
  v_lshlrev_b32 v8, 4, v1
  s_add_u32 s50, s46, 4
  s_add_u32 s51, s46, 8
  s_cmp_lt_u32 s46, 2
  s_cselect_b32 s51, s51, s46
  s_lshl_b32 s47, s46, 6
  v_add_u32 v12, s47, v1
  v_mul_u32_u24 v13, 820, v12
  v_lshrrev_b32 v13, 16, v13
  v_mul_u32_u24 v14, 80, v13
  v_sub_u32 v14, v12, v14
  v_mul_u32_u24 v9, 10240, v13
  v_lshl_add_u32 v9, v14, 4, v9
  s_lshl_b32 s52, s46, 10
  s_add_u32 s52, s52, 8192
  s_lshl_b32 s47, s50, 6
  v_add_u32 v12, s47, v1
  v_mul_u32_u24 v13, 820, v12
  v_lshrrev_b32 v13, 16, v13
  v_mul_u32_u24 v14, 80, v13
  v_sub_u32 v14, v12, v14
  v_mul_u32_u24 v10, 10240, v13
  v_lshl_add_u32 v10, v14, 4, v10
  s_lshl_b32 s53, s50, 10
  s_add_u32 s53, s53, 8192
  s_lshl_b32 s47, s51, 6
  v_add_u32 v12, s47, v1
  v_mul_u32_u24 v13, 820, v12
  v_lshrrev_b32 v13, 16, v13
  v_mul_u32_u24 v14, 80, v13
  v_sub_u32 v14, v12, v14
  v_mul_u32_u24 v11, 10240, v13
  v_lshl_add_u32 v11, v14, 4, v11
  s_lshl_b32 s54, s51, 10
  s_add_u32 s54, s54, 8192
  s_lshl_b32 s55, s46, 10
  s_lshl_b32 s47, s46, 7
  s_add_u32 s47, s47, 0
  v_add_u32 v12, s47, v1
  v_min_u32 v12, 469, v12
  v_mul_u32_u24 v13, 6554, v12
  v_lshrrev_b32 v13, 16, v13
  v_mul_u32_u24 v14, 10, v13
  v_sub_u32 v14, v12, v14
  v_mul_u32_u24 v13, 10240, v13
  v_lshl_add_u32 v13, v14, 7, v13
  s_and_b32 s47, s44, 3
  s_mul_i32 s47, s47, 481280
  s_mul_i32 s59, s45, 1280
  s_add_u32 s47, s47, s59
  s_lshl_b32 s47, s46, 7
  s_add_u32 s47, s47, 64
  v_add_u32 v12, s47, v1
  v_min_u32 v12, 469, v12
  v_mul_u32_u24 v13, 6554, v12
  v_lshrrev_b32 v13, 16, v13
  v_mul_u32_u24 v14, 10, v13
  v_sub_u32 v14, v12, v14
  v_mul_u32_u24 v13, 10240, v13
  v_lshl_add_u32 v13, v14, 7, v13
  s_and_b32 s47, s44, 3
  s_mul_i32 s47, s47, 481280
  s_mul_i32 s59, s45, 1280
  s_add_u32 s47, s47, s59
  s_mul_i32 s56, s45, 1280
  s_add_u32 s56, s56, 819200
  s_sub_u32 s56, s56, 81920
  s_cmp_ge_u32 s46, 2
  s_cbranch_scc1 L_k2_25
  s_add_u32 s56, s56, 81920
  s_add_u32 m0, s52, 0
  s_nop 0
  buffer_load_dwordx4 v9, s[32:35], s56 offen lds
  s_add_u32 m0, s53, 0
  s_nop 0
  buffer_load_dwordx4 v10, s[32:35], s56 offen lds
  s_add_u32 m0, s54, 0
  s_nop 0
  buffer_load_dwordx4 v11, s[32:35], s56 offen lds
  s_add_u32 s56, s56, 81920
  s_add_u32 m0, s52, 18432
  s_nop 0
  buffer_load_dwordx4 v9, s[32:35], s56 offen lds
  s_add_u32 m0, s53, 18432
  s_nop 0
  buffer_load_dwordx4 v10, s[32:35], s56 offen lds
  s_add_u32 m0, s54, 18432
  s_nop 0
  buffer_load_dwordx4 v11, s[32:35], s56 offen lds
  s_add_u32 s56, s56, 81920
  s_add_u32 m0, s52, 36864
  s_nop 0
  buffer_load_dwordx4 v9, s[32:35], s56 offen lds
  s_add_u32 m0, s53, 36864
  s_nop 0
  buffer_load_dwordx4 v10, s[32:35], s56 offen lds
  s_add_u32 m0, s54, 36864
  s_nop 0
  buffer_load_dwordx4 v11, s[32:35], s56 offen lds
  s_add_u32 s56, s56, 81920
  s_add_u32 m0, s52, 55296
  s_nop 0
  buffer_load_dwordx4 v9, s[32:35], s56 offen lds
  s_add_u32 m0, s53, 55296
  s_nop 0
  buffer_load_dwordx4 v10, s[32:35], s56 offen lds
  s_add_u32 m0, s54, 55296
  s_nop 0
  buffer_load_dwordx4 v11, s[32:35], s56 offen lds
  s_branch L_k2_26
L_k2_25:
  s_add_u32 s56, s56, 81920
  s_add_u32 m0, s52, 0
  s_nop 0
  buffer_load_dwordx4 v9, s[32:35], s56 offen lds
  s_add_u32 m0, s53, 0
  s_nop 0
  buffer_load_dwordx4 v10, s[32:35], s56 offen lds
  s_add_u32 s56, s56, 81920
  s_add_u32 m0, s52, 18432
  s_nop 0
  buffer_load_dwordx4 v9, s[32:35], s56 offen lds
  s_add_u32 m0, s53, 18432
  s_nop 0
  buffer_load_dwordx4 v10, s[32:35], s56 offen lds
  s_add_u32 s56, s56, 81920
  s_add_u32 m0, s52, 36864
  s_nop 0
  buffer_load_dwordx4 v9, s[32:35], s56 offen lds
  s_add_u32 m0, s53, 36864
  s_nop 0
  buffer_load_dwordx4 v10, s[32:35], s56 offen lds
  s_add_u32 s56, s56, 81920
  s_add_u32 m0, s52, 55296
  s_nop 0
  buffer_load_dwordx4 v9, s[32:35], s56 offen lds
  s_add_u32 m0, s53, 55296
  s_nop 0
  buffer_load_dwordx4 v10, s[32:35], s56 offen lds
L_k2_26:
L_F:
  s_setprio 3
  s_add_u32 s60, s26, 0x1b00000
  s_addc_u32 s61, s27, 0
  s_mov_b32 s62, 0x6000
  s_mov_b32 s63, 0x20000
  s_cmp_ge_u32 s40, 4
  s_cbranch_scc1 L_F_prod
  v_and_b32 v3, 15, v1
  v_lshrrev_b32 v4, 4, v1
  s_lshl_b32 s46, s40, 8
  v_lshlrev_b32 v7, 10, v4
  v_lshl_add_u32 v7, v3, 4, v7
  v_add_u32 v7, s46, v7
  v_mul_u32_u24 v8, 1280, v4
  v_lshl_add_u32 v8, v3, 4, v8
  v_add_u32 v8, 8192, v8
  v_mov_b32 v104, 0
  v_mov_b32 v105, 0
  v_mov_b32 v106, 0
  v_mov_b32 v107, 0
  v_mov_b32 v108, 0
  v_mov_b32 v109, 0
  v_mov_b32 v110, 0
  v_mov_b32 v111, 0
  v_mov_b32 v112, 0
  v_mov_b32 v113, 0
  v_mov_b32 v114, 0
  v_mov_b32 v115, 0
  v_mov_b32 v116, 0
  v_mov_b32 v117, 0
  v_mov_b32 v118, 0
  v_mov_b32 v119, 0
  v_mov_b32 v120, 0
  v_mov_b32 v121, 0
  v_mov_b32 v122, 0
  v_mov_b32 v123, 0
  v_mov_b32 v80, 0
  v_mov_b32 v81, 0
  v_mov_b32 v82, 0
  v_mov_b32 v83, 0
  v_mov_b32 v84, 0
  v_mov_b32 v85, 0
  v_mov_b32 v86, 0
  v_mov_b32 v87, 0
  v_mov_b32 v88, 0
  v_mov_b32 v89, 0
  v_mov_b32 v90, 0
  v_mov_b32 v91, 0
  v_mov_b32 v92, 0
  v_mov_b32 v93, 0
  v_mov_b32 v94, 0
  v_mov_b32 v95, 0
  v_mov_b32 v96, 0
  v_mov_b32 v97, 0
  v_mov_b32 v98, 0
  v_mov_b32 v99, 0
  v_mov_b32 v100, 0
  v_mov_b32 v101, 0
  v_mov_b32 v102, 0
  v_mov_b32 v103, 0
  s_barrier
  s_barrier
  s_mov_b32 s47, 0
  s_mov_b32 s48, 0
L_k2_27:
  ds_read_b128 v[32:35], v7 offset:0
  ds_read_b128 v[36:39], v8 offset:0
  v_mfma_f32_16x16x32_bf16 v[104:107], v[84:87], v[80:83], v[104:107]
  ds_read_b128 v[40:43], v8 offset:256
  ds_read_b128 v[44:47], v8 offset:512
  v_mfma_f32_16x16x32_bf16 v[108:111], v[88:91], v[80:83], v[108:111]
  ds_read_b128 v[48:51], v8 offset:768
  ds_read_b128 v[52:55], v8 offset:1024
  v_mfma_f32_16x16x32_bf16 v[112:115], v[92:95], v[80:83], v[112:115]
  ds_read_b128 v[56:59], v7 offset:4096
  ds_read_b128 v[60:63], v8 offset:5120
  v_mfma_f32_16x16x32_bf16 v[116:119], v[96:99], v[80:83], v[116:119]
  ds_read_b128 v[64:67], v8 offset:5376
  ds_read_b128 v[68:71], v8 offset:5632
  v_mfma_f32_16x16x32_bf16 v[120:123], v[100:103], v[80:83], v[120:123]
  ds_read_b128 v[72:75], v8 offset:5888
  ds_read_b128 v[76:79], v8 offset:6144
  s_waitcnt lgkmcnt(6)
  v_mfma_f32_16x16x32_bf16 v[104:107], v[36:39], v[32:35], v[104:107]
  v_mfma_f32_16x16x32_bf16 v[108:111], v[40:43], v[32:35], v[108:111]
  v_mfma_f32_16x16x32_bf16 v[112:115], v[44:47], v[32:35], v[112:115]
  v_mfma_f32_16x16x32_bf16 v[116:119], v[48:51], v[32:35], v[116:119]
  v_mfma_f32_16x16x32_bf16 v[120:123], v[52:55], v[32:35], v[120:123]
  s_add_u32 s48, s48, 1
  s_mov_b32 s49, 18432
  s_cmp_eq_u32 s48, 4
  s_cselect_b32 s49, -55296, s49
  s_cselect_b32 s48, 0, s48
  v_add_u32 v7, s49, v7
  v_add_u32 v8, s49, v8
  s_waitcnt lgkmcnt(0)
  s_barrier
  ds_read_b128 v[80:83], v7 offset:0
  ds_read_b128 v[84:87], v8 offset:0
  v_mfma_f32_16x16x32_bf16 v[104:107], v[60:63], v[56:59], v[104:107]
  ds_read_b128 v[88:91], v8 offset:256
  ds_read_b128 v[92:95], v8 offset:512
  v_mfma_f32_16x16x32_bf16 v[108:111], v[64:67], v[56:59], v[108:111]
  ds_read_b128 v[96:99], v8 offset:768
  ds_read_b128 v[100:103], v8 offset:1024
  v_mfma_f32_16x16x32_bf16 v[112:115], v[68:71], v[56:59], v[112:115]
  ds_read_b128 v[32:35], v7 offset:4096
  ds_read_b128 v[36:39], v8 offset:5120
  v_mfma_f32_16x16x32_bf16 v[116:119], v[72:75], v[56:59], v[116:119]
  ds_read_b128 v[40:43], v8 offset:5376
  ds_read_b128 v[44:47], v8 offset:5632
  v_mfma_f32_16x16x32_bf16 v[120:123], v[76:79], v[56:59], v[120:123]
  ds_read_b128 v[48:51], v8 offset:5888
  ds_read_b128 v[52:55], v8 offset:6144
  s_waitcnt lgkmcnt(6)
  v_mfma_f32_16x16x32_bf16 v[104:107], v[84:87], v[80:83], v[104:107]
  v_mfma_f32_16x16x32_bf16 v[108:111], v[88:91], v[80:83], v[108:111]
  v_mfma_f32_16x16x32_bf16 v[112:115], v[92:95], v[80:83], v[112:115]
  v_mfma_f32_16x16x32_bf16 v[116:119], v[96:99], v[80:83], v[116:119]
  v_mfma_f32_16x16x32_bf16 v[120:123], v[100:103], v[80:83], v[120:123]
  s_add_u32 s48, s48, 1
  s_mov_b32 s49, 18432
  s_cmp_eq_u32 s48, 4
  s_cselect_b32 s49, -55296, s49
  s_cselect_b32 s48, 0, s48
  v_add_u32 v7, s49, v7
  v_add_u32 v8, s49, v8
  s_waitcnt lgkmcnt(0)
  s_barrier
  ds_read_b128 v[56:59], v7 offset:0
  ds_read_b128 v[60:63], v8 offset:0
  v_mfma_f32_16x16x32_bf16 v[104:107], v[36:39], v[32:35], v[104:107]
  ds_read_b128 v[64:67], v8 offset:256
  ds_read_b128 v[68:71], v8 offset:512
  v_mfma_f32_16x16x32_bf16 v[108:111], v[40:43], v[32:35], v[108:111]
  ds_read_b128 v[72:75], v8 offset:768
  ds_read_b128 v[76:79], v8 offset:1024
  v_mfma_f32_16x16x32_bf16 v[112:115], v[44:47], v[32:35], v[112:115]
  ds_read_b128 v[80:83], v7 offset:4096
  ds_read_b128 v[84:87], v8 offset:5120
  v_mfma_f32_16x16x32_bf16 v[116:119], v[48:51], v[32:35], v[116:119]
  ds_read_b128 v[88:91], v8 offset:5376
  ds_read_b128 v[92:95], v8 offset:5632
  v_mfma_f32_16x16x32_bf16 v[120:123], v[52:55], v[32:35], v[120:123]
  ds_read_b128 v[96:99], v8 offset:5888
  ds_read_b128 v[100:103], v8 offset:6144
  s_waitcnt lgkmcnt(6)
  v_mfma_f32_16x16x32_bf16 v[104:107], v[60:63], v[56:59], v[104:107]
  v_mfma_f32_16x16x32_bf16 v[108:111], v[64:67], v[56:59], v[108:111]
  v_mfma_f32_16x16x32_bf16 v[112:115], v[68:71], v[56:59], v[112:115]
  v_mfma_f32_16x16x32_bf16 v[116:119], v[72:75], v[56:59], v[116:119]
  v_mfma_f32_16x16x32_bf16 v[120:123], v[76:79], v[56:59], v[120:123]
  s_add_u32 s48, s48, 1
  s_mov_b32 s49, 18432
  s_cmp_eq_u32 s48, 4
  s_cselect_b32 s49, -55296, s49
  s_cselect_b32 s48, 0, s48
  v_add_u32 v7, s49, v7
  v_add_u32 v8, s49, v8
  s_waitcnt lgkmcnt(0)
  s_barrier
  s_add_u32 s47, s47, 1
  s_cmp_lt_u32 s47, 8
  s_cbranch_scc1 L_k2_27
  v_mfma_f32_16x16x32_bf16 v[104:107], v[84:87], v[80:83], v[104:107]
  v_mfma_f32_16x16x32_bf16 v[108:111], v[88:91], v[80:83], v[108:111]
  v_mfma_f32_16x16x32_bf16 v[112:115], v[92:95], v[80:83], v[112:115]
  v_mfma_f32_16x16x32_bf16 v[116:119], v[96:99], v[80:83], v[116:119]
  v_mfma_f32_16x16x32_bf16 v[120:123], v[100:103], v[80:83], v[120:123]
  s_nop 7
  s_mov_b32 s36, s22
  s_mov_b32 s37, s23
  s_mov_b32 s38, 0x280000
  s_mov_b32 s39, 0x20000
  s_lshl_b32 s46, s44, 6
  s_lshl_b32 s47, s40, 4
  s_add_u32 s46, s46, s47
  v_add_u32 v9, s46, v3
  v_mul_u32_u24 v9, 1280, v9
  s_mul_i32 s46, s45, 160
  v_lshl_add_u32 v9, v4, 3, v9
  v_add_u32 v9, s46, v9
  v_cvt_pk_bf16_f32 v32, v104, v105
  v_cvt_pk_bf16_f32 v33, v106, v107
  v_cvt_pk_bf16_f32 v34, v108, v109
  v_cvt_pk_bf16_f32 v35, v110, v111
  v_cvt_pk_bf16_f32 v36, v112, v113
  v_cvt_pk_bf16_f32 v37, v114, v115
  v_cvt_pk_bf16_f32 v38, v116, v117
  v_cvt_pk_bf16_f32 v39, v118, v119
  v_cvt_pk_bf16_f32 v40, v120, v121
  v_cvt_pk_bf16_f32 v41, v122, v123
  buffer_store_dwordx2 v[32:33], v9, s[36:39], 0 offen offset:0
  buffer_store_dwordx2 v[34:35], v9, s[36:39], 0 offen offset:32
  buffer_store_dwordx2 v[36:37], v9, s[36:39], 0 offen offset:64
  buffer_store_dwordx2 v[38:39], v9, s[36:39], 0 offen offset:96
  buffer_store_dwordx2 v[40:41], v9, s[36:39], 0 offen offset:128
  s_endpgm
L_F_prod:
  s_cmp_lg_u32 s46, 0
  s_cbranch_scc1 L_k2_28
  s_lshl_b32 s47, s44, 7
  s_add_u32 s47, s47, 8192
  v_lshlrev_b32 v26, 2, v1
  v_cmp_gt_u32 vcc, 32, v1
  s_nop 1
  s_mov_b64 s[64:65], vcc
  s_mov_b32 s66, 0
L_k2_29:
  buffer_load_dword v27, v26, s[60:63], s47 offen sc1
  s_waitcnt vmcnt(0)
  v_cmp_ne_u32 vcc, 0, v27
  s_add_u32 s66, s66, 1
  s_nop 3
  s_and_b64 vcc, vcc, s[64:65]
  s_cmp_eq_u64 vcc, s[64:65]
  s_cbranch_scc1 L_k2_30
  s_sleep 4
  s_cmp_lt_u32 s66, 0x40000
  s_cbranch_scc1 L_k2_29
L_k2_30:
L_k2_28:
  s_barrier
  s_add_u32 s47, s46, 80
  s_lshl_b32 s48, s47, 15
  s_lshl_b32 s47, s44, 10
  s_add_u32 s48, s48, s47
  s_sub_u32 s48, s48, 262144
  s_add_u32 s49, s48, 131072
  s_add_u32 s59, s55, 0
  s_add_u32 m0, s59, 0
  s_add_u32 s48, s48, 262144
  buffer_load_dwordx4 v8, s[28:31], s48 offen sc1 lds
  s_add_u32 s59, s55, 0
  s_add_u32 m0, s59, 4096
  s_add_u32 s49, s49, 262144
  buffer_load_dwordx4 v8, s[28:31], s49 offen sc1 lds
  s_add_u32 s59, s55, 18432
  s_add_u32 m0, s59, 0
  s_add_u32 s48, s48, 262144
  buffer_load_dwordx4 v8, s[28:31], s48 offen sc1 lds
  s_add_u32 s59, s55, 18432
  s_add_u32 m0, s59, 4096
  s_add_u32 s49, s49, 262144
  buffer_load_dwordx4 v8, s[28:31], s49 offen sc1 lds
  s_add_u32 s59, s55, 36864
  s_add_u32 m0, s59, 0
  s_add_u32 s48, s48, 262144
  buffer_load_dwordx4 v8, s[28:31], s48 offen sc1 lds
  s_add_u32 s59, s55, 36864
  s_add_u32 m0, s59, 4096
  s_add_u32 s49, s49, 262144
  buffer_load_dwordx4 v8, s[28:31], s49 offen sc1 lds
  s_add_u32 s59, s55, 55296
  s_add_u32 m0, s59, 0
  s_add_u32 s48, s48, 262144
  buffer_load_dwordx4 v8, s[28:31], s48 offen sc1 lds
  s_add_u32 s59, s55, 55296
  s_add_u32 m0, s59, 4096
  s_add_u32 s49, s49, 262144
  buffer_load_dwordx4 v8, s[28:31], s49 offen sc1 lds
  s_waitcnt vmcnt(6)
  s_barrier
  s_mov_b32 s58, 0
  s_add_u32 s57, s55, 4096
  s_cmp_ge_u32 s46, 2
  s_cbranch_scc1 L_k2_31
  s_waitcnt vmcnt(4)
  s_barrier
  s_add_u32 m0, s55, s58
  s_add_u32 s48, s48, 262144
  buffer_load_dwordx4 v8, s[28:31], s48 offen sc1 lds
  s_add_u32 m0, s57, s58
  s_add_u32 s49, s49, 262144
  buffer_load_dwordx4 v8, s[28:31], s49 offen sc1 lds
  s_add_u32 m0, s52, s58
  s_add_u32 s56, s56, 81920
  buffer_load_dwordx4 v9, s[32:35], s56 offen lds
  s_add_u32 m0, s53, s58
  s_add_u32 s59, s58, 18432
  buffer_load_dwordx4 v10, s[32:35], s56 offen lds
  s_add_u32 m0, s54, s58
  s_cmp_eq_u32 s59, 73728
  buffer_load_dwordx4 v11, s[32:35], s56 offen lds
  s_cselect_b32 s58, 0, s59
  s_waitcnt vmcnt(7)
  s_barrier
  s_add_u32 m0, s55, s58
  s_add_u32 s48, s48, 262144
  buffer_load_dwordx4 v8, s[28:31], s48 offen sc1 lds
  s_add_u32 m0, s57, s58
  s_add_u32 s49, s49, 262144
  buffer_load_dwordx4 v8, s[28:31], s49 offen sc1 lds
  s_add_u32 m0, s52, s58
  s_add_u32 s56, s56, 81920
  buffer_load_dwordx4 v9, s[32:35], s56 offen lds
  s_add_u32 m0, s53, s58
  s_add_u32 s59, s58, 18432
  buffer_load_dwordx4 v10, s[32:35], s56 offen lds
  s_add_u32 m0, s54, s58
  s_cmp_eq_u32 s59, 73728
  buffer_load_dwordx4 v11, s[32:35], s56 offen lds
  s_cselect_b32 s58, 0, s59
  s_mov_b32 s47, 8
L_k2_32:
  s_waitcnt vmcnt(10)
  s_barrier
  s_add_u32 m0, s55, s58
  s_add_u32 s48, s48, 262144
  buffer_load_dwordx4 v8, s[28:31], s48 offen sc1 lds
  s_add_u32 m0, s57, s58
  s_add_u32 s49, s49, 262144
  buffer_load_dwordx4 v8, s[28:31], s49 offen sc1 lds
  s_add_u32 m0, s52, s58
  s_add_u32 s56, s56, 81920
  buffer_load_dwordx4 v9, s[32:35], s56 offen lds
  s_add_u32 m0, s53, s58
  s_add_u32 s59, s58, 18432
  buffer_load_dwordx4 v10, s[32:35], s56 offen lds
  s_add_u32 m0, s54, s58
  s_cmp_eq_u32 s59, 73728
  buffer_load_dwordx4 v11, s[32:35], s56 offen lds
  s_cselect_b32 s58, 0, s59
  s_sub_u32 s47, s47, 1
  s_cmp_lg_u32 s47, 0
  s_cbranch_scc1 L_k2_32
  s_cmp_lg_u32 s46, 0
  s_cbranch_scc1 L_k2_33
  s_lshr_b32 s47, s44, 2
  s_lshl_b32 s47, s47, 10
  s_add_u32 s47, s47, 16384
  v_lshlrev_b32 v26, 4, v1
  s_mov_b32 s66, 0
L_k2_34:
  buffer_load_dwordx4 v[28:31], v26, s[60:63], s47 offen sc1
  s_waitcnt vmcnt(0)
  v_and_b32 v28, v28, v29
  v_and_b32 v30, v30, v31
  v_and_b32 v28, v28, v30
  v_cmp_ne_u32 vcc, 0, v28
  s_add_u32 s66, s66, 1
  s_nop 3
  s_cmp_eq_u64 vcc, -1
  s_cbranch_scc1 L_k2_35
  s_sleep 4
  s_cmp_lt_u32 s66, 0x40000
  s_cbranch_scc1 L_k2_34
L_k2_35:
L_k2_33:
  s_waitcnt vmcnt(10)
  s_barrier
  s_add_u32 s47, s46, 0
  s_lshl_b32 s48, s47, 15
  s_lshl_b32 s47, s44, 10
  s_add_u32 s48, s48, s47
  s_sub_u32 s48, s48, 262144
  s_add_u32 s49, s48, 131072
  s_mul_i32 s56, s45, 1280
  s_add_u32 s56, s56, 0
  s_sub_u32 s56, s56, 81920
  s_add_u32 m0, s55, s58
  s_add_u32 s48, s48, 262144
  buffer_load_dwordx4 v8, s[28:31], s48 offen sc1 lds
  s_add_u32 m0, s57, s58
  s_add_u32 s49, s49, 262144
  buffer_load_dwordx4 v8, s[28:31], s49 offen sc1 lds
  s_add_u32 m0, s52, s58
  s_add_u32 s56, s56, 81920
  buffer_load_dwordx4 v9, s[32:35], s56 offen lds
  s_add_u32 m0, s53, s58
  s_add_u32 s59, s58, 18432
  buffer_load_dwordx4 v10, s[32:35], s56 offen lds
  s_add_u32 m0, s54, s58
  s_cmp_eq_u32 s59, 73728
  buffer_load_dwordx4 v11, s[32:35], s56 offen lds
  s_cselect_b32 s58, 0, s59
  s_mov_b32 s47, 9
L_k2_36:
  s_waitcnt vmcnt(10)
  s_barrier
  s_add_u32 m0, s55, s58
  s_add_u32 s48, s48, 262144
  buffer_load_dwordx4 v8, s[28:31], s48 offen sc1 lds
  s_add_u32 m0, s57, s58
  s_add_u32 s49, s49, 262144
  buffer_load_dwordx4 v8, s[28:31], s49 offen sc1 lds
  s_add_u32 m0, s52, s58
  s_add_u32 s56, s56, 81920
  buffer_load_dwordx4 v9, s[32:35], s56 offen lds
  s_add_u32 m0, s53, s58
  s_add_u32 s59, s58, 18432
  buffer_load_dwordx4 v10, s[32:35], s56 offen lds
  s_add_u32 m0, s54, s58
  s_cmp_eq_u32 s59, 73728
  buffer_load_dwordx4 v11, s[32:35], s56 offen lds
  s_cselect_b32 s58, 0, s59
  s_sub_u32 s47, s47, 1
  s_cmp_lg_u32 s47, 0
  s_cbranch_scc1 L_k2_36
  s_waitcnt vmcnt(10)
  s_barrier
  s_waitcnt vmcnt(5)
  s_barrier
  s_waitcnt vmcnt(0)
  s_barrier
  s_waitcnt vmcnt(0)
  s_barrier
  s_endpgm
L_k2_31:
  s_waitcnt vmcnt(4)
  s_barrier
  s_add_u32 m0, s55, s58
  s_add_u32 s48, s48, 262144
  buffer_load_dwordx4 v8, s[28:31], s48 offen sc1 lds
  s_add_u32 m0, s57, s58
  s_add_u32 s49, s49, 262144
  buffer_load_dwordx4 v8, s[28:31], s49 offen sc1 lds
  s_add_u32 m0, s52, s58
  s_add_u32 s56, s56, 81920
  buffer_load_dwordx4 v9, s[32:35], s56 offen lds
  s_add_u32 m0, s53, s58
  s_add_u32 s59, s58, 18432
  buffer_load_dwordx4 v10, s[32:35], s56 offen lds
  s_cmp_eq_u32 s59, 73728
  s_cselect_b32 s58, 0, s59
  s_waitcnt vmcnt(6)
  s_barrier
  s_add_u32 m0, s55, s58
  s_add_u32 s48, s48, 262144
  buffer_load_dwordx4 v8, s[28:31], s48 offen sc1 lds
  s_add_u32 m0, s57, s58
  s_add_u32 s49, s49, 262144
  buffer_load_dwordx4 v8, s[28:31], s49 offen sc1 lds
  s_add_u32 m0, s52, s58
  s_add_u32 s56, s56, 81920
  buffer_load_dwordx4 v9, s[32:35], s56 offen lds
  s_add_u32 m0, s53, s58
  s_add_u32 s59, s58, 18432
  buffer_load_dwordx4 v10, s[32:35], s56 offen lds
  s_cmp_eq_u32 s59, 73728
  s_cselect_b32 s58, 0, s59
  s_mov_b32 s47, 8
L_k2_37:
  s_waitcnt vmcnt(8)
  s_barrier
  s_add_u32 m0, s55, s58
  s_add_u32 s48, s48, 262144
  buffer_load_dwordx4 v8, s[28:31], s48 offen sc1 lds
  s_add_u32 m0, s57, s58
  s_add_u32 s49, s49, 262144
  buffer_load_dwordx4 v8, s[28:31], s49 offen sc1 lds
  s_add_u32 m0, s52, s58
  s_add_u32 s56, s56, 81920
  buffer_load_dwordx4 v9, s[32:35], s56 offen lds
  s_add_u32 m0, s53, s58
  s_add_u32 s59, s58, 18432
  buffer_load_dwordx4 v10, s[32:35], s56 offen lds
  s_cmp_eq_u32 s59, 73728
  s_cselect_b32 s58, 0, s59
  s_sub_u32 s47, s47, 1
  s_cmp_lg_u32 s47, 0
  s_cbranch_scc1 L_k2_37
  s_waitcnt vmcnt(8)
  s_barrier
  s_add_u32 s47, s46, 0
  s_lshl_b32 s48, s47, 15
  s_lshl_b32 s47, s44, 10
  s_add_u32 s48, s48, s47
  s_sub_u32 s48, s48, 262144
  s_add_u32 s49, s48, 131072
  s_mul_i32 s56, s45, 1280
  s_add_u32 s56, s56, 0
  s_sub_u32 s56, s56, 81920
  s_add_u32 m0, s55, s58
  s_add_u32 s48, s48, 262144
  buffer_load_dwordx4 v8, s[28:31], s48 offen sc1 lds
  s_add_u32 m0, s57, s58
  s_add_u32 s49, s49, 262144
  buffer_load_dwordx4 v8, s[28:31], s49 offen sc1 lds
  s_add_u32 m0, s52, s58
  s_add_u32 s56, s56, 81920
  buffer_load_dwordx4 v9, s[32:35], s56 offen lds
  s_add_u32 m0, s53, s58
  s_add_u32 s59, s58, 18432
  buffer_load_dwordx4 v10, s[32:35], s56 offen lds
  s_cmp_eq_u32 s59, 73728
  s_cselect_b32 s58, 0, s59
  s_mov_b32 s47, 9
L_k2_38:
  s_waitcnt vmcnt(8)
  s_barrier
  s_add_u32 m0, s55, s58
  s_add_u32 s48, s48, 262144
  buffer_load_dwordx4 v8, s[28:31], s48 offen sc1 lds
  s_add_u32 m0, s57, s58
  s_add_u32 s49, s49, 262144
  buffer_load_dwordx4 v8, s[28:31], s49 offen sc1 lds
  s_add_u32 m0, s52, s58
  s_add_u32 s56, s56, 81920
  buffer_load_dwordx4 v9, s[32:35], s56 offen lds
  s_add_u32 m0, s53, s58
  s_add_u32 s59, s58, 18432
  buffer_load_dwordx4 v10, s[32:35], s56 offen lds
  s_cmp_eq_u32 s59, 73728
  s_cselect_b32 s58, 0, s59
  s_sub_u32 s47, s47, 1
  s_cmp_lg_u32 s47, 0
  s_cbranch_scc1 L_k2_38
  s_waitcnt vmcnt(8)
  s_barrier
  s_waitcnt vmcnt(4)
  s_barrier
  s_waitcnt vmcnt(0)
  s_barrier
  s_waitcnt vmcnt(0)
  s_barrier
  s_endpgm
L_k2_end:
  s_endpgm
L_code_end:
.fill 64, 4, 0xBF800000
.section .rodata,"a"
.p2align 6
.amdhsa_kernel k1_kernel
  .amdhsa_next_free_vgpr 128
  .amdhsa_next_free_sgpr 102
  .amdhsa_accum_offset 128
  .amdhsa_group_segment_fixed_size 0
  .amdhsa_kernarg_size 96
  .amdhsa_user_sgpr_count 2
  .amdhsa_user_sgpr_kernarg_segment_ptr 1
  .amdhsa_system_sgpr_workgroup_id_x 1
.end_amdhsa_kernel
.p2align 6
.amdhsa_kernel k2_kernel
  .amdhsa_next_free_vgpr 128
  .amdhsa_next_free_sgpr 102
  .amdhsa_accum_offset 128
  .amdhsa_group_segment_fixed_size 0
  .amdhsa_kernarg_size 96
  .amdhsa_user_sgpr_count 2
  .amdhsa_user_sgpr_kernarg_segment_ptr 1
  .amdhsa_system_sgpr_workgroup_id_x 1
.end_amdhsa_kernel
```
